```python
import torch

def _softmax(x, axis=-1):
    return torch.softmax(x, dim=axis)
def _gelu(x):
    return torch.nn.functional.gelu(x, approximate="tanh")
def _silu(x):
    return torch.nn.functional.silu(x)
def _sigmoid(x):
    return torch.sigmoid(x)
def _layernorm(x, axis=-1, eps=1e-5):
    m = x.mean(dim=axis, keepdim=True)
    v = x.var(dim=axis, keepdim=True, unbiased=False)
    return (x - m) / torch.sqrt(v + eps)
def _scatter_add(tgt, idx, src, axis=0):
    return tgt.clone().index_add_(axis, idx, src)
def _segment_sum(src, seg, n):
    out = torch.zeros((n,) + src.shape[1:], dtype=src.dtype)
    return out.index_add_(0, seg, src)
def _pad(x, pw):
    flat = tuple(v for pair in reversed(pw) for v in pair)
    return torch.nn.functional.pad(x, flat)

kernel_name = 'recurrent_scan__spectral_gfnet__glu_gated_swiglu__prompt'

def setup_inputs():

    _w = (lambda a: (lambda t: t.to(torch.bfloat16) if t.is_floating_point() else t)(torch.as_tensor(a)))
    def _A_setup():
        B, S, D = 1, 2048, 448
        Df = D // 2 + 1
        return {
            "x": _w((lambda *s: torch.randn(*s, dtype=torch.bfloat16) * 0.2)(B, S, D)),
            "w_r": _w((lambda *s: torch.randn(*s, dtype=torch.bfloat16) * 1.6)(S, Df) * 0.02),
            "w_i": _w((lambda *s: torch.randn(*s, dtype=torch.bfloat16) * 1.6)(S, Df) * 0.02),
        }
    _A_in = _A_setup()

    def _B_setup():
        B, S, D, F = 1, 2048, 448, 1792
        return {
            "x": _w((lambda *s: torch.randn(*s, dtype=torch.bfloat16) * 0.2)(B, S, D)),
            "w1": _w((lambda *s: torch.randn(*s, dtype=torch.bfloat16) * 0.8)(D, F) * (2.0 / D) ** 0.5),
            "w3": _w((lambda *s: torch.randn(*s, dtype=torch.bfloat16) * 0.8)(D, F) * (2.0 / D) ** 0.5),
            "w2": _w((lambda *s: torch.randn(*s, dtype=torch.bfloat16) * 0.8)(F, D) * (2.0 / F) ** 0.5),
        }
    _B_in = _B_setup()

    return {
        "A_x": _A_in["x"],
        "A_w_r": _A_in["w_r"],
        "A_w_i": _A_in["w_i"],
        "B_x": _B_in["x"],
        "B_w1": _B_in["w1"],
        "B_w3": _B_in["w3"],
        "B_w2": _B_in["w2"],
    }

def reference(A_x, A_w_r, A_w_i, B_x, B_w1, B_w3, B_w2):
    def _A_ref(x, w_r, w_i):
        B, S, D = x.shape
        X = (lambda x, axes=(-2,-1): torch.fft.rfft2(x.float(), dim=axes))(x, axes=(-2, -1))
        W = w_r + 1j * w_i
        X = X * W
        y = (lambda x, s, axes=(-2,-1): torch.fft.irfft2(x, s=s, dim=axes).to(torch.bfloat16))(X, (S, D), axes=(-2, -1))
        return y

    def _B_ref(x, w1, w3, w2):
        gate = torch.einsum("bsd,df->bsf", x, w1)
        up = torch.einsum("bsd,df->bsf", x, w3)
        h = _silu(gate) * up
        out = torch.einsum("bsf,fd->bsd", h, w2)
        return out

    x = A_x
    xn = _layernorm(x, axis=-1)
    s = _A_ref(xn, A_w_r, A_w_i)
    g = _silu(_B_ref(xn, B_w1, B_w3, B_w2))
    return x + s * g
```

```asm
; @launch grid=(256,1,1) block=(256,1,1) lds=163840
.amdgcn_target "amdgcn-amd-amdhsa--gfx950"
.text
.globl recurrent_scan__spectral_gfnet__glu_gated_swiglu__prompt_kernel
.p2align 8
.type recurrent_scan__spectral_gfnet__glu_gated_swiglu__prompt_kernel,@function
recurrent_scan__spectral_gfnet__glu_gated_swiglu__prompt_kernel:

    s_cmp_ge_u32 s2, 256
    s_cbranch_scc1 L_end
    s_getpc_b64 s[66:67]
    s_lshl_b32 s3, s2, 7
    s_and_b32 s3, s3, 0x7c00
    s_add_u32 s66, s66, s3
    s_addc_u32 s67, s67, 0
    v_lshlrev_b32 v1, 2, v0
    v_mov_b32 v3, s67
    v_add_co_u32 v2, vcc, s66, v1
    s_load_dwordx2 s[24:25], s[0:1], 0
    v_lshrrev_b32 v1, 6, v0
    v_addc_co_u32 v3, vcc, 0, v3, vcc
    global_load_dword v4, v[2:3], off
    s_load_dwordx2 s[28:29], s[0:1], 32
    s_load_dwordx2 s[32:33], s[0:1], 40
    s_lshr_b32 s57, s2, 3
    v_readfirstlane_b32 s52, v1
    v_and_b32 v0, 63, v0
    s_cmp_ge_u32 s57, 28
    s_cbranch_scc1 L_helper

    s_and_b32 s63, s2, 3
    s_mul_i32 s67, s57, 37
    s_lshr_b32 s67, s67, 8
    v_lshrrev_b32 v24, 3, v0
    v_lshrrev_b32 v25, 4, v0
    v_and_b32_e64 v2, 7, v0
    s_lshl_b32 s55, s63, 2
    s_add_u32 s55, s55, s67
    s_lshl_b32 s48, s55, 2
    s_add_u32 s48, s48, s52
    s_mul_i32 s66, s48, 28672
    v_mul_u32_u24 v3, 896, v24
    v_xor_b32_e64 v12, v2, v25
    v_add_u32 v3, s66, v3
    s_lshr_b32 s65, s2, 1
    s_xor_b32 s65, s65, s2
    s_bitcmp1_b32 s65, 2
    s_cselect_b32 s65, 3, 0
    s_add_u32 s65, s65, s63
    s_lshl_b32 s70, s65, 7
    v_lshl_add_u32 v8, v12, 4, v3
    s_lshl_b32 s69, s52, 12
    s_mov_b32 s26, 0x1c0000
    s_mov_b32 s27, 0x20000
    s_mov_b32 m0, s69
    s_waitcnt lgkmcnt(0)
    buffer_load_dwordx4 v8, s[24:27], s70 offen lds
    v_add_u32 v10, 12288, v8
    v_xor_b32_e64 v12, 4, v12
    buffer_load_dwordx4 v10, s[24:27], s70 offen offset:2048 lds
    v_lshl_add_u32 v9, v12, 4, v3
    v_add_u32 v9, 6144, v9
    buffer_load_dwordx4 v9, s[24:27], s70 offen offset:1024 lds
    v_add_u32 v11, 12288, v9
    s_bfe_u32 s64, s2, 0x10002
    s_mul_i32 s60, s67, 7
    s_sub_u32 s60, s57, s60
    buffer_load_dwordx4 v11, s[24:27], s70 offen offset:3072 lds
    s_mul_i32 s56, s64, 7
    s_add_u32 s56, s56, s60
    s_mul_i32 s77, s65, 229376
    s_mul_i32 s67, s52, 57344
    s_lshl_b32 s66, s56, 8
    s_add_u32 s67, s67, s66
    v_mul_u32_u24 v16, 3584, v24
    v_and_b32 v17, 1, v25
    v_add_u32 v16, s67, v16
    v_lshlrev_b32 v17, 1, v17
    v_xor_b32 v17, v2, v17
    s_mov_b32 s30, 0x188000
    s_mov_b32 s31, 0x20000
    s_add_u32 m0, s69, 49152
    v_lshl_add_u32 v12, v17, 4, v16
    buffer_load_dwordx4 v12, s[28:31], s77 offen lds
    v_add_u32 v13, 27648, v12
    v_xor_b32_e64 v17, 4, v17
    buffer_load_dwordx4 v13, s[28:31], s77 offen offset:1024 lds
    s_add_u32 m0, s69, 51200
    v_lshl_add_u32 v14, v17, 4, v16
    s_mov_b32 s34, 0x188000
    s_mov_b32 s35, 0x20000
    buffer_load_dwordx4 v14, s[32:35], s77 offen lds
    v_add_u32 v15, 27648, v14
    buffer_load_dwordx4 v15, s[32:35], s77 offen offset:1024 lds
    s_load_dwordx2 s[44:45], s[0:1], 72
    v_lshlrev_b32_e64 v1, 4, v0
    s_lshr_b32 s53, s52, 1
    s_and_b32 s54, s52, 1
    s_mov_b32 s101, s2
    s_and_b32 s58, s2, 7
    s_load_dwordx2 s[36:37], s[0:1], 48
    s_load_dwordx2 s[40:41], s[0:1], 56
    s_add_u32 s65, s65, 1
    s_cmp_eq_u32 s65, 7
    s_cselect_b32 s65, 0, s65
    s_lshl_b32 s71, s65, 7
    s_mul_i32 s78, s65, 229376
    s_add_u32 m0, s69, 16384
    s_nop 0
    buffer_load_dwordx4 v8, s[24:27], s71 offen lds
    buffer_load_dwordx4 v9, s[24:27], s71 offen offset:1024 lds
    buffer_load_dwordx4 v10, s[24:27], s71 offen offset:2048 lds
    buffer_load_dwordx4 v11, s[24:27], s71 offen offset:3072 lds
    s_waitcnt lgkmcnt(0)
    s_load_dword s62, s[44:45], 0
    s_mov_b32 s46, 0x1500000
    s_mov_b32 s47, 0x20000
    s_mov_b32 s38, 0x188000
    s_mov_b32 s39, 0x20000
    s_mov_b32 s42, 0x1c0000
    s_mov_b32 s43, 0x20000
    s_mul_i32 s61, s58, 28
    s_add_u32 s61, s61, s57
    v_and_b32 v26, 15, v0
    v_lshrrev_b32 v27, 5, v0
    v_and_b32_e64 v28, 1, v25
    s_add_u32 s65, s65, 1
    s_cmp_eq_u32 s65, 7
    s_cselect_b32 s65, 0, s65
    s_lshl_b32 s72, s65, 7
    s_mul_i32 s79, s65, 229376
    s_add_u32 s65, s65, 1
    s_cmp_eq_u32 s65, 7
    s_cselect_b32 s65, 0, s65
    s_lshl_b32 s73, s65, 7
    s_mul_i32 s80, s65, 229376
    s_add_u32 s65, s65, 1
    s_cmp_eq_u32 s65, 7
    s_cselect_b32 s65, 0, s65
    s_lshl_b32 s74, s65, 7
    s_mul_i32 s81, s65, 229376
    s_add_u32 s65, s65, 1
    s_cmp_eq_u32 s65, 7
    s_cselect_b32 s65, 0, s65
    s_lshl_b32 s75, s65, 7
    s_mul_i32 s82, s65, 229376
    s_add_u32 s65, s65, 1
    s_cmp_eq_u32 s65, 7
    s_cselect_b32 s65, 0, s65
    s_lshl_b32 s76, s65, 7
    s_mul_i32 s83, s65, 229376
    v_and_b32 v29, 31, v0
    s_lshl_b32 s65, s56, 4
    s_add_u32 s65, s65, 1
    v_lshrrev_b32 v3, 1, v29
    v_add_u32 v3, s65, v3
    v_cvt_f32_u32 v3, v3
    v_mul_f32 v3, 0x3b124925, v3
    v_and_b32 v132, 1, v0
    v_cvt_f32_u32 v132, v132
    v_cos_f32 v133, v3
    v_mul_f32 v132, 0x3e800000, v132
    s_lshl_b32 s65, s52, 4
    v_lshl_add_u32 v134, v27, 3, s65
    v_add_f32_e64 v133, v133, v133
    v_lshrrev_b32 v135, 2, s69
    v_add_u32_e64 v135, v135, v1
    v_add_u32 v135, 98304, v135
    s_lshr_b32 s65, s70, 1
    v_add_u32 v16, s65, v134
    v_cvt_f32_u32_e64 v16, v16
    v_fma_f32 v16, v16, v3, v132
    v_add_f32 v17, v16, v3
    v_cos_f32 v16, v16
    v_cos_f32 v17, v17
    s_nop 0
    v_fma_f32 v18, v133, v17, -v16
    v_fma_f32 v19, v133, v18, -v17
    v_cvt_pk_bf16_f32 v38, v16, v17
    v_fma_f32 v20, v133, v19, -v18
    v_fma_f32 v21, v133, v20, -v19
    v_cvt_pk_bf16_f32 v39, v18, v19
    v_fma_f32 v22, v133, v21, -v20
    v_fma_f32 v23, v133, v22, -v21
    v_cvt_pk_bf16_f32 v40, v20, v21
    v_cvt_pk_bf16_f32 v41, v22, v23
    s_waitcnt lgkmcnt(0)
    s_mul_i32 s62, s62, 0x9e3779b1
    s_add_u32 s62, s62, 0x7f4a7c15
    ds_write_b128 v135, v[38:41]
    s_lshr_b32 s65, s71, 1
    v_add_u32 v30, s65, v134
    v_cvt_f32_u32 v30, v30
    v_fma_f32 v30, v30, v3, v132
    v_add_f32 v31, v30, v3
    v_cos_f32 v30, v30
    v_cos_f32 v31, v31
    s_nop 0
    v_fma_f32 v32, v133, v31, -v30
    v_fma_f32 v33, v133, v32, -v31
    v_cvt_pk_bf16_f32 v46, v30, v31
    v_fma_f32 v34, v133, v33, -v32
    v_fma_f32 v35, v133, v34, -v33
    v_cvt_pk_bf16_f32 v47, v32, v33
    v_fma_f32 v36, v133, v35, -v34
    v_fma_f32 v37, v133, v36, -v35
    v_cvt_pk_bf16_f32 v48, v34, v35
    v_cvt_pk_bf16_f32 v49, v36, v37
    ds_write_b128 v135, v[46:49] offset:4096
    s_lshr_b32 s65, s72, 1
    v_add_u32 v16, s65, v134
    v_cvt_f32_u32_e64 v16, v16
    v_fma_f32 v16, v16, v3, v132
    v_add_f32 v17, v16, v3
    v_cos_f32 v16, v16
    v_cos_f32 v17, v17
    s_nop 0
    v_fma_f32 v18, v133, v17, -v16
    v_fma_f32 v19, v133, v18, -v17
    v_cvt_pk_bf16_f32 v50, v16, v17
    v_fma_f32 v20, v133, v19, -v18
    v_fma_f32 v21, v133, v20, -v19
    v_cvt_pk_bf16_f32 v51, v18, v19
    v_fma_f32 v22, v133, v21, -v20
    v_fma_f32 v23, v133, v22, -v21
    v_cvt_pk_bf16_f32 v52, v20, v21
    v_cvt_pk_bf16_f32 v53, v22, v23
    ds_write_b128 v135, v[50:53] offset:8192
    s_lshr_b32 s65, s73, 1
    v_add_u32 v38, s65, v134
    v_cvt_f32_u32_e64 v38, v38
    v_fma_f32 v38, v38, v3, v132
    v_add_f32 v39, v38, v3
    v_cos_f32 v38, v38
    v_cos_f32 v39, v39
    s_nop 0
    v_fma_f32 v40, v133, v39, -v38
    v_fma_f32 v41, v133, v40, -v39
    v_cvt_pk_bf16_f32 v46, v38, v39
    v_fma_f32 v42, v133, v41, -v40
    v_fma_f32 v43, v133, v42, -v41
    v_cvt_pk_bf16_f32 v47, v40, v41
    v_fma_f32 v44, v133, v43, -v42
    v_fma_f32 v45, v133, v44, -v43
    v_cvt_pk_bf16_f32 v48, v42, v43
    v_cvt_pk_bf16_f32 v49, v44, v45
    ds_write_b128 v135, v[46:49] offset:12288
    s_lshr_b32 s65, s74, 1
    v_add_u32 v30, s65, v134
    v_cvt_f32_u32_e64 v30, v30
    v_fma_f32 v30, v30, v3, v132
    v_add_f32 v31, v30, v3
    v_cos_f32 v30, v30
    v_cos_f32 v31, v31
    s_nop 0
    v_fma_f32 v32, v133, v31, -v30
    v_fma_f32 v33, v133, v32, -v31
    v_cvt_pk_bf16_f32 v50, v30, v31
    v_fma_f32 v34, v133, v33, -v32
    v_fma_f32 v35, v133, v34, -v33
    v_cvt_pk_bf16_f32 v51, v32, v33
    v_fma_f32 v36, v133, v35, -v34
    v_fma_f32 v37, v133, v36, -v35
    v_cvt_pk_bf16_f32 v52, v34, v35
    v_cvt_pk_bf16_f32 v53, v36, v37
    ds_write_b128 v135, v[50:53] offset:16384
    s_lshr_b32 s65, s75, 1
    v_add_u32 v16, s65, v134
    v_cvt_f32_u32_e64 v16, v16
    v_fma_f32 v16, v16, v3, v132
    v_add_f32 v17, v16, v3
    v_cos_f32 v16, v16
    v_cos_f32 v17, v17
    s_nop 0
    v_fma_f32 v18, v133, v17, -v16
    v_fma_f32 v19, v133, v18, -v17
    v_cvt_pk_bf16_f32 v38, v16, v17
    v_fma_f32 v20, v133, v19, -v18
    v_fma_f32 v21, v133, v20, -v19
    v_cvt_pk_bf16_f32 v39, v18, v19
    v_fma_f32 v22, v133, v21, -v20
    v_fma_f32 v23, v133, v22, -v21
    v_cvt_pk_bf16_f32 v40, v20, v21
    v_cvt_pk_bf16_f32 v41, v22, v23
    ds_write_b128 v135, v[38:41] offset:20480
    v_lshrrev_b32 v42, 3, v29
    v_lshlrev_b32 v42, 10, v42
    v_lshl_add_u32 v42, v2, 7, v42
    v_add_u32_e64 v42, s69, v42
    v_bfe_u32 v33, v0, 1, 3
    v_xor_b32_e64 v33, v27, v33
    v_lshl_add_u32 v140, v33, 4, v42
    v_xor_b32 v144, 4096, v140
    v_xor_b32_e64 v34, 2, v33
    v_lshl_add_u32 v141, v34, 4, v42
    v_xor_b32 v145, 4096, v141
    v_xor_b32_e64 v34, 4, v33
    v_lshl_add_u32 v142, v34, 4, v42
    v_xor_b32 v146, 4096, v142
    v_xor_b32_e64 v34, 6, v33
    v_lshl_add_u32 v143, v34, 4, v42
    v_xor_b32 v147, 4096, v143
    v_bfe_u32 v30, v0, 2, 2
    v_and_b32 v31, 3, v0
    v_lshlrev_b32 v35, 11, v28
    v_lshl_add_u32 v35, v27, 10, v35
    v_lshl_add_u32 v35, v30, 7, v35
    v_lshl_add_u32 v35, v31, 3, v35
    v_add_u32 v35, 49152, v35
    v_lshrrev_b32_e64 v18, 1, v30
    v_lshl_add_u32 v18, v28, 1, v18
    s_lshl_b32 s65, s54, 1
    v_xor_b32 v18, s65, v18
    v_lshl_add_u32 v16, v18, 5, v35
    v_xor_b32 v17, 32, v16
    v_add_u32 v32, 98304, v1
    s_lshl_b32 s65, s64, 2
    s_add_u32 s65, s65, s60
    s_lshl_b32 s11, s55, 3
    s_add_u32 s11, s11, s65
    s_lshl_b32 s11, s11, 2
    s_add_u32 s11, s11, s52
    s_mul_i32 s68, s11, 3584
    s_cmp_lt_u32 s60, 4
    s_cselect_b32 s68, s68, 0x7ffffff0
    s_cselect_b32 s11, s11, 0x1ffffff
    v_mul_u32_u24 v22, 896, v25
    v_lshl_add_u32 v22, v26, 4, v22
    v_cmp_gt_u32 vcc, 8, v26
    v_mov_b32 v23, 0x7ffffff0
    s_nop 0
    v_cndmask_b32 v23, v23, v22, vcc
    s_lshl_b32 s59, s55, 1
    s_add_u32 s59, s59, s64
    v_cmp_eq_u32 vcc, 0, v0
    v_mov_b32 v33, 0x7ffffff0
    v_mov_b32_e64 v34, s62
    v_cndmask_b32 v33, v33, 0, vcc
    s_and_b32 s65, s59, 1
    s_lshl_b32 s65, s65, 1
    s_add_u32 s65, s65, s54
    s_xor_b32 s65, s65, s52
    s_lshl_b32 s65, s65, 12
    s_lshl_b32 s66, s53, 6
    s_or_b32 s65, s65, s66
    v_xor_b32 v18, s65, v140
    v_xor_b32 v19, 32, v18
    s_lshl_b32 s91, s60, 7
    v_add_u32 v20, 65536, v16
    v_add_u32 v21, 65536, v17
    s_add_u32 m0, s69, 65536
    s_nop 0
    buffer_load_dwordx4 v12, s[28:31], s78 offen lds
    buffer_load_dwordx4 v13, s[28:31], s78 offen offset:1024 lds
    s_add_u32 m0, s69, 67584
    s_nop 0
    buffer_load_dwordx4 v14, s[32:35], s78 offen lds
    buffer_load_dwordx4 v15, s[32:35], s78 offen offset:1024 lds
    s_waitcnt vmcnt(8) lgkmcnt(0)
    s_barrier
    ds_read_b64_tr_b16 a[24:25], v16
    ds_read_b64_tr_b16 a[26:27], v16 offset:512
    ds_read_b64_tr_b16 a[28:29], v17
    ds_read_b64_tr_b16 a[30:31], v17 offset:512
    ds_read_b128 a[0:3], v140
    ds_read_b128 a[4:7], v144
    ds_read_b128 a[56:59], v32
    ds_read_b64_tr_b16 a[32:33], v16 offset:4096
    ds_read_b64_tr_b16 a[34:35], v16 offset:4608
    ds_read_b64_tr_b16 a[36:37], v17 offset:4096
    ds_read_b64_tr_b16 a[38:39], v17 offset:4608
    ds_read_b128 a[8:11], v141
    ds_read_b128 a[12:15], v145
    ds_read_b128 a[64:67], v32 offset:1024
    s_waitcnt lgkmcnt(7)
    v_mfma_f32_32x32x16_bf16 v[44:59], a[24:27], a[0:3], 0
    s_cmp_eq_u32 s70, s91
    s_cselect_b64 exec, -1, 0
    ds_read_b128 v[214:217], v18
    ds_read_b128 v[218:221], v19
    s_mov_b64 exec, -1
    s_add_u32 m0, s69, 32768
    v_mfma_f32_32x32x16_bf16 v[60:75], a[24:27], a[4:7], 0
    ds_read_b64_tr_b16 a[40:41], v16 offset:8192
    ds_read_b64_tr_b16 a[42:43], v16 offset:8704
    buffer_load_dwordx4 v8, s[24:27], s72 offen lds
    s_lshr_b32 s63, s76, 1
    v_add_u32 v124, s63, v134
    v_mfma_f32_32x32x16_bf16 v[76:91], a[28:31], a[0:3], 0
    ds_read_b64_tr_b16 a[44:45], v17 offset:8192
    ds_read_b64_tr_b16 a[46:47], v17 offset:8704
    buffer_load_dwordx4 v9, s[24:27], s72 offen offset:1024 lds
    v_cvt_f32_u32_e64 v124, v124
    v_fma_f32 v124, v124, v3, v132
    v_mfma_f32_32x32x16_bf16 v[92:107], a[28:31], a[4:7], 0
    ds_read_b128 a[16:19], v142
    ds_read_b128 a[20:23], v146
    v_add_f32 v125, v124, v3
    v_cos_f32 v124, v124
    v_mfma_f32_32x32x16_bf16 v[108:123], a[0:3], a[56:59], 0
    ds_read_b128 a[72:75], v32 offset:2048
    buffer_load_dwordx4 v10, s[24:27], s72 offen offset:2048 lds
    v_cos_f32 v125, v125
    s_waitcnt lgkmcnt(9)
    v_mfma_f32_32x32x16_bf16 v[44:59], a[32:35], a[8:11], v[44:59]
    ds_read_b64_tr_b16 a[48:49], v16 offset:12288
    ds_read_b64_tr_b16 a[50:51], v16 offset:12800
    v_fma_f32 v126, v133, v125, -v124
    v_fma_f32 v127, v133, v126, -v125
    v_cvt_pk_bf16_f32 v38, v124, v125
    v_fma_f32 v128, v133, v127, -v126
    v_mfma_f32_32x32x16_bf16 v[60:75], a[32:35], a[12:15], v[60:75]
    ds_read_b64_tr_b16 a[52:53], v17 offset:12288
    ds_read_b64_tr_b16 a[54:55], v17 offset:12800
    buffer_load_dwordx4 v11, s[24:27], s72 offen offset:3072 lds
    v_fma_f32 v129, v133, v128, -v127
    v_cvt_pk_bf16_f32 v39, v126, v127
    v_mfma_f32_32x32x16_bf16 v[76:91], a[36:39], a[8:11], v[76:91]
    ds_read_b128 a[24:27], v143
    s_add_u32 m0, s69, 81920
    v_fma_f32 v130, v133, v129, -v128
    v_fma_f32 v131, v133, v130, -v129
    v_cvt_pk_bf16_f32 v40, v128, v129
    v_cvt_pk_bf16_f32 v41, v130, v131
    v_mfma_f32_32x32x16_bf16 v[92:107], a[36:39], a[12:15], v[92:107]
    ds_read_b128 a[28:31], v147
    buffer_load_dwordx4 v12, s[28:31], s79 offen lds
    ds_write_b128 v135, v[38:41] offset:24576
    v_mfma_f32_32x32x16_bf16 v[108:123], a[8:11], a[64:67], v[108:123]
    ds_read_b128 a[80:83], v32 offset:3072
    buffer_load_dwordx4 v13, s[28:31], s79 offen offset:1024 lds
    v_lshlrev_b32_e64 v35, 6, v26
    v_lshl_add_u32 v35, v27, 5, v35
    s_waitcnt lgkmcnt(8)
    v_mfma_f32_32x32x16_bf16 v[44:59], a[40:43], a[16:19], v[44:59]
    s_add_u32 m0, s69, 83968
    v_lshl_add_u32 v35, v28, 4, v35
    s_lshl_b32 s12, s56, 17
    s_lshl_b32 s2, s48, 11
    s_add_u32 s12, s12, s2
    s_add_u32 s12, s12, 1048576
    v_mfma_f32_32x32x16_bf16 v[60:75], a[40:43], a[20:23], v[60:75]
    buffer_load_dwordx4 v14, s[32:35], s79 offen lds
    v_lshlrev_b32 v36, 6, v26
    v_lshl_add_u32 v36, v25, 4, v36
    s_lshl_b32 s17, s61, 13
    s_lshl_b32 s2, s52, 10
    v_mfma_f32_32x32x16_bf16 v[76:91], a[44:47], a[16:19], v[76:91]
    s_waitcnt vmcnt(7) lgkmcnt(0)
    s_barrier
    ds_read_b64_tr_b16 a[56:57], v16 offset:16384
    s_add_u32 s17, s17, s2
    s_add_u32 s17, s17, 3145728
    s_add_u32 s23, s17, 4096
    v_mfma_f32_32x32x16_bf16 v[92:107], a[44:47], a[20:23], v[92:107]
    ds_read_b64_tr_b16 a[58:59], v16 offset:16896
    ds_read_b64_tr_b16 a[60:61], v17 offset:16384
    ds_read_b64_tr_b16 a[62:63], v17 offset:16896
    buffer_load_dwordx4 v15, s[32:35], s79 offen offset:1024 lds
    s_and_b32 s2, s55, 3
    v_mfma_f32_32x32x16_bf16 v[108:123], a[16:19], a[72:75], v[108:123]
    ds_read_b128 a[32:35], v140 offset:16384
    ds_read_b128 a[36:39], v144 offset:16384
    ds_read_b128 a[88:91], v32 offset:4096
    s_lshl_b32 s2, s2, 1
    s_add_u32 s2, s2, s60
    v_mfma_f32_32x32x16_bf16 v[44:59], a[48:51], a[24:27], v[44:59]
    ds_read_b64_tr_b16 a[64:65], v16 offset:20480
    ds_read_b64_tr_b16 a[66:67], v16 offset:20992
    buffer_load_dwordx4 v[124:127], v22, s[24:27], s68 offen
    s_cmp_ge_u32 s2, 7
    s_cselect_b32 s3, 7, 0
    v_mfma_f32_32x32x16_bf16 v[60:75], a[48:51], a[28:31], v[60:75]
    ds_read_b64_tr_b16 a[68:69], v17 offset:20480
    ds_read_b64_tr_b16 a[70:71], v17 offset:20992
    s_sub_u32 s2, s2, s3
    s_sub_u32 s3, s56, s60
    s_add_u32 s2, s2, s3
    s_mul_i32 s4, s2, 114688
    v_mfma_f32_32x32x16_bf16 v[76:91], a[52:55], a[24:27], v[76:91]
    ds_read_b128 a[40:43], v141 offset:16384
    buffer_load_dwordx4 v[128:131], v22, s[24:27], s68 offen offset:256
    s_mul_i32 s3, s3, 114688
    s_add_u32 s2, s3, 802816
    s_add_u32 s5, s4, 114688
    v_mfma_f32_32x32x16_bf16 v[92:107], a[52:55], a[28:31], v[92:107]
    ds_read_b128 a[44:47], v145 offset:16384
    s_cmp_ge_u32 s5, s2
    s_cselect_b32 s5, s3, s5
    s_add_u32 s6, s5, 114688
    s_cmp_ge_u32 s6, s2
    s_cselect_b32 s6, s3, s6
    v_mfma_f32_32x32x16_bf16 v[108:123], a[24:27], a[80:83], v[108:123]
    ds_read_b128 a[96:99], v32 offset:5120
    buffer_load_dwordx4 v[132:135], v22, s[24:27], s68 offen offset:512
    s_add_u32 s7, s6, 114688
    s_waitcnt lgkmcnt(7)
    v_mfma_f32_32x32x16_bf16 v[44:59], a[56:59], a[32:35], v[44:59]
    s_cmp_eq_u32 s71, s91
    s_cselect_b64 exec, -1, 0
    ds_read_b128 v[214:217], v18 offset:16384
    ds_read_b128 v[218:221], v19 offset:16384
    s_mov_b64 exec, -1
    v_mfma_f32_32x32x16_bf16 v[60:75], a[56:59], a[36:39], v[60:75]
    ds_read_b64_tr_b16 a[72:73], v16 offset:24576
    ds_read_b64_tr_b16 a[74:75], v16 offset:25088
    buffer_load_dwordx4 v[136:139], v23, s[24:27], s68 offen offset:768
    s_cmp_ge_u32 s7, s2
    s_cselect_b32 s7, s3, s7
    v_mfma_f32_32x32x16_bf16 v[76:91], a[60:63], a[32:35], v[76:91]
    ds_read_b64_tr_b16 a[76:77], v17 offset:24576
    ds_read_b64_tr_b16 a[78:79], v17 offset:25088
    s_add_u32 m0, s69, 131072
    s_add_u32 s8, s7, 114688
    s_cmp_ge_u32 s8, s2
    s_cselect_b32 s8, s3, s8
    v_mfma_f32_32x32x16_bf16 v[92:107], a[60:63], a[36:39], v[92:107]
    ds_read_b128 a[48:51], v142 offset:16384
    ds_read_b128 a[52:55], v146 offset:16384
    buffer_load_dwordx4 v8, s[24:27], s73 offen lds
    s_add_u32 s9, s8, 114688
    v_mfma_f32_32x32x16_bf16 v[108:123], a[32:35], a[88:91], v[108:123]
    ds_read_b128 a[104:107], v32 offset:6144
    s_cmp_ge_u32 s9, s2
    s_cselect_b32 s9, s3, s9
    s_add_u32 s10, s9, 114688
    s_waitcnt lgkmcnt(9)
    v_mfma_f32_32x32x16_bf16 v[44:59], a[64:67], a[40:43], v[44:59]
    ds_read_b64_tr_b16 a[80:81], v16 offset:28672
    ds_read_b64_tr_b16 a[82:83], v16 offset:29184
    s_mul_i32 s90, s48, 25088
    s_lshl_b32 s89, s56, 8
    s_add_u32 s90, s90, s89
    v_min_u32 v3, 6, v0
    v_mfma_f32_32x32x16_bf16 v[60:75], a[64:67], a[44:47], v[60:75]
    ds_read_b64_tr_b16 a[84:85], v17 offset:28672
    ds_read_b64_tr_b16 a[86:87], v17 offset:29184
    v_mul_u32_u24 v3, 3584, v3
    buffer_load_dword v149, v3, s[28:31], s90 offen offset:128
    v_mfma_f32_32x32x16_bf16 v[76:91], a[68:71], a[40:43], v[76:91]
    ds_read_b128 a[56:59], v143 offset:16384
    buffer_load_dword v150, v3, s[32:35], s90 offen offset:128
    s_cmp_ge_u32 s10, s2
    s_cselect_b32 s10, s3, s10
    s_mul_i32 s2, s52, 14336
    v_mfma_f32_32x32x16_bf16 v[92:107], a[68:71], a[44:47], v[92:107]
    ds_read_b128 a[60:63], v147 offset:16384
    s_mul_i32 s89, s56, 64
    s_add_u32 s89, s89, s48
    s_mul_i32 s89, s89, 1792
    v_min_u32 v4, 13, v0
    v_lshlrev_b32 v4, 7, v4
    v_mfma_f32_32x32x16_bf16 v[108:123], a[40:43], a[96:99], v[108:123]
    ds_read_b128 a[108:111], v32 offset:7168
    buffer_load_dword v148, v4, s[36:39], s89 offen
    s_lshl_b32 s3, s60, 7
    s_add_u32 s2, s2, s3
    s_waitcnt lgkmcnt(7)
    v_mfma_f32_32x32x16_bf16 v[44:59], a[72:75], a[48:51], v[44:59]
    buffer_load_dwordx4 v9, s[24:27], s73 offen offset:1024 lds
    v_mul_u32_u24 v5, 896, v24
    v_add_u32 v5, s2, v5
    v_lshlrev_b32 v37, 2, v28
    v_xor_b32 v37, v2, v37
    v_mfma_f32_32x32x16_bf16 v[60:75], a[72:75], a[52:55], v[60:75]
    buffer_load_dwordx4 v10, s[24:27], s73 offen offset:2048 lds
    v_lshl_add_u32 v6, v37, 4, v5
    v_add_u32 v7, 6144, v6
    v_lshl_add_u32 v3, v27, 2, v30
    v_lshlrev_b32_e64 v3, 7, v3
    v_mfma_f32_32x32x16_bf16 v[76:91], a[76:79], a[48:51], v[76:91]
    s_waitcnt vmcnt(10) lgkmcnt(0)
    s_barrier
    ds_read_b64_tr_b16 a[88:89], v16 offset:32768
    buffer_load_dwordx4 v11, s[24:27], s73 offen offset:3072 lds
    v_lshl_add_u32 v3, v28, 5, v3
    v_mfma_f32_32x32x16_bf16 v[92:107], a[76:79], a[52:55], v[92:107]
    ds_read_b64_tr_b16 a[90:91], v16 offset:33280
    ds_read_b64_tr_b16 a[92:93], v17 offset:32768
    ds_read_b64_tr_b16 a[94:95], v17 offset:33280
    s_add_u32 m0, s69, 147456
    v_lshl_add_u32 v3, v31, 3, v3
    v_add_u32_e64 v3, s69, v3
    v_mfma_f32_32x32x16_bf16 v[108:123], a[48:51], a[104:107], v[108:123]
    ds_read_b128 a[64:67], v140 offset:32768
    ds_read_b128 a[68:71], v144 offset:32768
    ds_read_b128 a[120:123], v32 offset:8192
    buffer_load_dwordx4 v12, s[28:31], s80 offen lds
    v_mfma_f32_32x32x16_bf16 v[44:59], a[80:83], a[56:59], v[44:59]
    ds_read_b64_tr_b16 a[96:97], v16 offset:36864
    ds_read_b64_tr_b16 a[98:99], v16 offset:37376
    v_lshrrev_b32 v4, 1, v30
    v_xor_b32 v4, s53, v4
    v_lshl_add_u32 v22, v4, 6, v3
    v_xor_b32_e64 v23, 64, v22
    v_mfma_f32_32x32x16_bf16 v[60:75], a[80:83], a[60:63], v[60:75]
    ds_read_b64_tr_b16 a[100:101], v17 offset:36864
    ds_read_b64_tr_b16 a[102:103], v17 offset:37376
    buffer_load_dwordx4 v13, s[28:31], s80 offen offset:1024 lds
    s_lshl_b32 s16, s48, 10
    s_lshl_b32 s2, s56, 6
    v_mfma_f32_32x32x16_bf16 v[76:91], a[84:87], a[56:59], v[76:91]
    ds_read_b128 a[72:75], v141 offset:32768
    s_add_u32 m0, s69, 149504
    s_add_u32 s16, s16, s2
    s_add_u32 s16, s16, 524288
    s_mul_i32 s20, s56, 114688
    s_lshl_b32 s2, s54, 11
    v_mfma_f32_32x32x16_bf16 v[92:107], a[84:87], a[60:63], v[92:107]
    ds_read_b128 a[76:79], v145 offset:32768
    buffer_load_dwordx4 v14, s[32:35], s80 offen lds
    s_add_u32 s20, s20, s2
    s_add_u32 s20, s20, 8388608
    s_xor_b32 s3, s48, 0
    v_mfma_f32_32x32x16_bf16 v[108:123], a[56:59], a[108:111], v[108:123]
    ds_read_b128 a[124:127], v32 offset:9216
    s_mul_i32 s2, s3, 4682
    s_lshr_b32 s2, s2, 16
    s_mul_i32 s14, s2, 1490944
    s_lshl_b32 s2, s3, 13
    s_mov_b32 s67, 0x3f803f80
    s_waitcnt vmcnt(13)
    v_dot2_f32_bf16 v4, v124, s67, 0
    v_dot2_f32_bf16 v5, v124, v124, 0
    v_dot2_f32_bf16 v4, v125, s67, v4
    v_dot2_f32_bf16 v5, v125, v125, v5
    v_dot2_f32_bf16 v4, v126, s67, v4
    v_dot2_f32_bf16 v5, v126, v126, v5
    v_dot2_f32_bf16 v4, v127, s67, v4
    v_dot2_f32_bf16 v5, v127, v127, v5
    s_waitcnt vmcnt(12)
    v_dot2_f32_bf16 v4, v128, s67, v4
    v_dot2_f32_bf16 v5, v128, v128, v5
    v_dot2_f32_bf16 v4, v129, s67, v4
    v_dot2_f32_bf16 v5, v129, v129, v5
    v_dot2_f32_bf16 v4, v130, s67, v4
    v_dot2_f32_bf16 v5, v130, v130, v5
    v_dot2_f32_bf16 v4, v131, s67, v4
    v_dot2_f32_bf16 v5, v131, v131, v5
    s_waitcnt vmcnt(11)
    v_dot2_f32_bf16 v4, v132, s67, v4
    v_dot2_f32_bf16 v5, v132, v132, v5
    v_dot2_f32_bf16 v4, v133, s67, v4
    v_dot2_f32_bf16 v5, v133, v133, v5
    v_dot2_f32_bf16 v4, v134, s67, v4
    v_dot2_f32_bf16 v5, v134, v134, v5
    v_dot2_f32_bf16 v4, v135, s67, v4
    v_dot2_f32_bf16 v5, v135, v135, v5
    s_waitcnt vmcnt(10)
    v_dot2_f32_bf16 v4, v136, s67, v4
    v_dot2_f32_bf16 v5, v136, v136, v5
    v_dot2_f32_bf16 v4, v137, s67, v4
    v_dot2_f32_bf16 v5, v137, v137, v5
    v_dot2_f32_bf16 v4, v138, s67, v4
    v_dot2_f32_bf16 v5, v138, v138, v5
    v_dot2_f32_bf16 v4, v139, s67, v4
    v_dot2_f32_bf16 v5, v139, v139, v5
    s_waitcnt lgkmcnt(7)
    v_mfma_f32_32x32x16_bf16 v[44:59], a[88:91], a[64:67], v[44:59]
    s_cmp_eq_u32 s72, s91
    s_cselect_b64 exec, -1, 0
    ds_read_b128 v[214:217], v18 offset:32768
    ds_read_b128 v[218:221], v19 offset:32768
    s_mov_b64 exec, -1
    v_lshlrev_b32_e64 v3, 27, v26
    v_mfma_f32_32x32x16_bf16 v[60:75], a[88:91], a[68:71], v[60:75]
    ds_read_b64_tr_b16 a[104:105], v16 offset:40960
    ds_read_b64_tr_b16 a[106:107], v16 offset:41472
    buffer_load_dwordx4 v15, s[32:35], s80 offen offset:1024 lds
    v_lshl_add_u32 v42, v25, 4, v3
    v_mov_b32_e64 v40, s62
    v_mfma_f32_32x32x16_bf16 v[76:91], a[92:95], a[64:67], v[76:91]
    ds_read_b64_tr_b16 a[108:109], v17 offset:40960
    ds_read_b64_tr_b16 a[110:111], v17 offset:41472
    s_add_u32 m0, s69, 0
    v_add_f32_dpp v4, v4, v4 row_ror:8 row_mask:0xf bank_mask:0xf
    v_add_f32_dpp v5, v5, v5 row_ror:8 row_mask:0xf bank_mask:0xf
    v_mov_b32 v41, s62
    v_mfma_f32_32x32x16_bf16 v[92:107], a[92:95], a[68:71], v[92:107]
    ds_read_b128 a[80:83], v142 offset:32768
    ds_read_b128 a[84:87], v146 offset:32768
    buffer_load_dwordx4 v8, s[24:27], s74 offen lds
    v_add_f32_dpp v4, v4, v4 row_ror:4 row_mask:0xf bank_mask:0xf
    v_add_f32_dpp v5, v5, v5 row_ror:4 row_mask:0xf bank_mask:0xf
    v_mfma_f32_32x32x16_bf16 v[108:123], a[64:67], a[120:123], v[108:123]
    ds_read_b128 a[136:139], v32 offset:10240
    buffer_load_dwordx4 v9, s[24:27], s74 offen offset:1024 lds
    s_lshl_b32 s18, s11, 6
    v_add_f32_dpp v4, v4, v4 row_ror:2 row_mask:0xf bank_mask:0xf
    s_waitcnt lgkmcnt(9)
    v_mfma_f32_32x32x16_bf16 v[44:59], a[96:99], a[72:75], v[44:59]
    ds_read_b64_tr_b16 a[112:113], v16 offset:45056
    ds_read_b64_tr_b16 a[114:115], v16 offset:45568
    v_add_f32_dpp v5, v5, v5 row_ror:2 row_mask:0xf bank_mask:0xf
    s_add_u32 s18, s18, 65536
    v_add_f32_dpp v4, v4, v4 row_ror:1 row_mask:0xf bank_mask:0xf
    v_add_f32_dpp v5, v5, v5 row_ror:1 row_mask:0xf bank_mask:0xf
    v_mfma_f32_32x32x16_bf16 v[60:75], a[96:99], a[76:79], v[60:75]
    ds_read_b64_tr_b16 a[116:117], v17 offset:45056
    ds_read_b64_tr_b16 a[118:119], v17 offset:45568
    buffer_load_dwordx4 v10, s[24:27], s74 offen offset:2048 lds
    v_mul_f32 v3, 0x3b124925, v4
    v_mul_f32 v43, 0x3b124925, v5
    v_mfma_f32_32x32x16_bf16 v[76:91], a[100:103], a[72:75], v[76:91]
    ds_read_b128 a[88:91], v143 offset:32768
    v_fma_f32 v43, -v3, v3, v43
    v_max_f32_e64 v43, 0, v43
    v_cvt_pk_bf16_f32 v43, v43, v43
    v_lshlrev_b32_e64 v43, 16, v43
    v_add_f32 v43, 0x3727c5ac, v43
    v_mfma_f32_32x32x16_bf16 v[92:107], a[100:103], a[76:79], v[92:107]
    ds_read_b128 a[92:95], v147 offset:32768
    buffer_load_dwordx4 v11, s[24:27], s74 offen offset:3072 lds
    v_cvt_pk_bf16_f32 v43, v43, v43
    v_lshlrev_b32 v43, 16, v43
    s_add_u32 s14, s14, s2
    v_mfma_f32_32x32x16_bf16 v[108:123], a[72:75], a[124:127], v[108:123]
    ds_read_b128 a[144:147], v32 offset:11264
    s_add_u32 m0, s69, 49152
    v_sqrt_f32 v43, v43
    v_cvt_pk_bf16_f32 v38, -v3, -v3
    s_waitcnt lgkmcnt(7)
    v_mfma_f32_32x32x16_bf16 v[44:59], a[104:107], a[80:83], v[44:59]
    buffer_load_dwordx4 v12, s[28:31], s81 offen lds
    v_cvt_pk_bf16_f32 v43, v43, v43
    v_lshlrev_b32 v39, 16, v43
    s_add_u32 s14, s14, s20
    s_xor_b32 s3, s48, 1
    v_mfma_f32_32x32x16_bf16 v[60:75], a[104:107], a[84:87], v[60:75]
    buffer_store_dwordx4 v[38:41], v42, s[44:47], s18 offen sc1
    s_mul_i32 s2, s3, 4682
    s_lshr_b32 s2, s2, 16
    s_mul_i32 s15, s2, 1490944
    s_lshl_b32 s2, s3, 13
    v_mfma_f32_32x32x16_bf16 v[76:91], a[108:111], a[80:83], v[76:91]
    s_waitcnt vmcnt(6) lgkmcnt(0)
    s_barrier
    v_xor_b32 v140, 131072, v140
    v_xor_b32 v144, 131072, v144
    buffer_load_dwordx4 v13, s[28:31], s81 offen offset:1024 lds
    v_mfma_f32_32x32x16_bf16 v[92:107], a[108:111], a[84:87], v[92:107]
    ds_read_b64_tr_b16 a[120:121], v20 offset:32768
    ds_read_b64_tr_b16 a[122:123], v20 offset:33280
    ds_read_b64_tr_b16 a[124:125], v21 offset:32768
    ds_read_b64_tr_b16 a[126:127], v21 offset:33280
    s_add_u32 m0, s69, 51200
    s_add_u32 s15, s15, s2
    v_mfma_f32_32x32x16_bf16 v[108:123], a[80:83], a[136:139], v[108:123]
    ds_read_b128 a[96:99], v140
    ds_read_b128 a[100:103], v144
    ds_read_b128 a[152:155], v32 offset:12288
    buffer_load_dwordx4 v14, s[32:35], s81 offen lds
    v_mfma_f32_32x32x16_bf16 v[44:59], a[112:115], a[88:91], v[44:59]
    v_xor_b32 v141, 131072, v141
    v_xor_b32 v145, 131072, v145
    buffer_load_dwordx4 v15, s[32:35], s81 offen offset:1024 lds
    s_add_u32 s15, s15, s20
    s_lshl_b32 s2, s52, 2
    v_mfma_f32_32x32x16_bf16 v[60:75], a[112:115], a[92:95], v[60:75]
    ds_read_b64_tr_b16 a[128:129], v20 offset:36864
    ds_read_b64_tr_b16 a[130:131], v20 offset:37376
    s_add_u32 m0, s69, 16384
    s_lshl_b32 s84, s56, 4
    s_add_u32 s84, s84, s55
    s_lshl_b32 s84, s84, 6
    v_mfma_f32_32x32x16_bf16 v[76:91], a[116:119], a[88:91], v[76:91]
    ds_read_b64_tr_b16 a[132:133], v21 offset:36864
    ds_read_b64_tr_b16 a[134:135], v21 offset:37376
    buffer_load_dwordx4 v8, s[24:27], s75 offen lds
    s_add_u32 s84, s84, s2
    s_add_u32 s84, s84, 8192
    v_mfma_f32_32x32x16_bf16 v[92:107], a[116:119], a[92:95], v[92:107]
    ds_read_b128 a[104:107], v141
    ds_read_b128 a[108:111], v145
    s_lshl_b32 s85, s61, 6
    s_add_u32 s85, s85, s2
    s_add_u32 s85, s85, 36864
    s_lshl_b32 s86, s56, 11
    v_mfma_f32_32x32x16_bf16 v[108:123], a[88:91], a[144:147], v[108:123]
    ds_read_b128 a[156:159], v32 offset:13312
    buffer_load_dwordx4 v9, s[24:27], s75 offen offset:1024 lds
    s_add_u32 s86, s86, 290816
    s_lshl_b32 s87, s61, 2
    s_waitcnt lgkmcnt(7)
    v_mfma_f32_32x32x16_bf16 v[44:59], a[120:123], a[96:99], v[44:59]
    v_xor_b32 v18, 131072, v18
    v_xor_b32 v19, 131072, v19
    s_cmp_eq_u32 s73, s91
    s_cselect_b64 exec, -1, 0
    ds_read_b128 v[214:217], v18
    ds_read_b128 v[218:221], v19
    s_mov_b64 exec, -1
    v_mfma_f32_32x32x16_bf16 v[60:75], a[120:123], a[100:103], v[60:75]
    v_xor_b32 v142, 131072, v142
    v_xor_b32 v146, 131072, v146
    ds_read_b64_tr_b16 a[136:137], v20 offset:40960
    buffer_load_dwordx4 v10, s[24:27], s75 offen offset:2048 lds
    s_add_u32 s87, s87, s52
    v_mfma_f32_32x32x16_bf16 v[76:91], a[124:127], a[96:99], v[76:91]
    ds_read_b64_tr_b16 a[138:139], v20 offset:41472
    ds_read_b64_tr_b16 a[140:141], v21 offset:40960
    s_lshl_b32 s87, s87, 11
    s_add_u32 s87, s87, 5242880
    s_lshr_b32 s49, s61, 4
    s_lshl_b32 s49, s49, 10
    v_mfma_f32_32x32x16_bf16 v[92:107], a[124:127], a[100:103], v[92:107]
    ds_read_b64_tr_b16 a[142:143], v21 offset:41472
    ds_read_b128 a[112:115], v142
    buffer_load_dwordx4 v11, s[24:27], s75 offen offset:3072 lds
    s_add_u32 s49, s49, 8192
    s_mul_i32 s51, s52, 3584
    v_mfma_f32_32x32x16_bf16 v[108:123], a[96:99], a[152:155], v[108:123]
    ds_read_b128 a[116:119], v146
    ds_read_b128 a[168:171], v32 offset:14336
    s_add_u32 m0, s69, 65536
    s_add_u32 s51, s51, 36864
    v_lshrrev_b32 v38, 2, v0
    s_waitcnt lgkmcnt(9)
    v_mfma_f32_32x32x16_bf16 v[44:59], a[128:131], a[104:107], v[44:59]
    v_xor_b32 v143, 131072, v143
    v_xor_b32 v147, 131072, v147
    buffer_load_dwordx4 v12, s[28:31], s82 offen lds
    v_lshlrev_b32 v38, 4, v38
    v_add_u32 v38, v38, v31
    v_mfma_f32_32x32x16_bf16 v[60:75], a[128:131], a[108:111], v[60:75]
    ds_read_b64_tr_b16 a[144:145], v20 offset:45056
    ds_read_b64_tr_b16 a[146:147], v20 offset:45568
    v_lshlrev_b32 v38, 2, v38
    s_lshr_b32 s88, s61, 4
    s_lshl_b32 s88, s88, 17
    s_and_b32 s3, s61, 15
    v_mfma_f32_32x32x16_bf16 v[76:91], a[132:135], a[104:107], v[76:91]
    ds_read_b64_tr_b16 a[148:149], v21 offset:45056
    ds_read_b64_tr_b16 a[150:151], v21 offset:45568
    buffer_load_dwordx4 v13, s[28:31], s82 offen offset:1024 lds
    s_lshl_b32 s3, s3, 7
    s_add_u32 s88, s88, s3
    v_mfma_f32_32x32x16_bf16 v[92:107], a[132:135], a[108:111], v[92:107]
    ds_read_b128 a[120:123], v143
    ds_read_b128 a[124:127], v147
    s_add_u32 m0, s69, 67584
    s_lshl_b32 s3, s52, 15
    s_add_u32 s88, s88, s3
    s_add_u32 s88, s88, 1048576
    v_mfma_f32_32x32x16_bf16 v[108:123], a[104:107], a[156:159], v[108:123]
    ds_read_b128 a[176:179], v32 offset:15360
    buffer_load_dwordx4 v14, s[32:35], s82 offen lds
    s_lshl_b32 s13, s52, 11
    v_lshl_add_u32 v39, v27, 2, v28
    s_waitcnt lgkmcnt(7)
    v_mfma_f32_32x32x16_bf16 v[44:59], a[136:139], a[112:115], v[44:59]
    v_xor_b32 v39, v2, v39
    v_lshlrev_b32 v39, 4, v39
    v_lshl_add_u32 v39, v24, 11, v39
    v_min_u32 v3, 55, v0
    v_lshlrev_b32 v3, 6, v3
    v_lshlrev_b32_e64 v40, 6, v29
    v_mfma_f32_32x32x16_bf16 v[60:75], a[136:139], a[116:119], v[60:75]
    buffer_load_dwordx4 v15, s[32:35], s82 offen offset:1024 lds
    v_lshlrev_b32_e64 v41, 7, v26
    v_lshl_add_u32 v41, v25, 4, v41
    v_min_u32 v42, 6, v2
    v_lshlrev_b32 v42, 6, v42
    v_mfma_f32_32x32x16_bf16 v[76:91], a[140:143], a[112:115], v[76:91]
    s_waitcnt vmcnt(8) lgkmcnt(0)
    s_barrier
    v_xor_b32 v140, 131072, v140
    v_xor_b32 v144, 131072, v144
    s_add_u32 m0, s69, 32768
    v_and_b32_e64 v4, 1, v24
    v_mfma_f32_32x32x16_bf16 v[92:107], a[140:143], a[116:119], v[92:107]
    ds_read_b64_tr_b16 a[152:153], v16
    ds_read_b64_tr_b16 a[154:155], v16 offset:512
    ds_read_b64_tr_b16 a[156:157], v17
    ds_read_b64_tr_b16 a[158:159], v17 offset:512
    buffer_load_dwordx4 v8, s[24:27], s76 offen lds
    v_mfma_f32_32x32x16_bf16 v[108:123], a[112:115], a[168:171], v[108:123]
    ds_read_b128 a[128:131], v140
    ds_read_b128 a[132:135], v144
    ds_read_b128 a[184:187], v32 offset:16384
    buffer_load_dwordx4 v9, s[24:27], s76 offen offset:1024 lds
    v_mfma_f32_32x32x16_bf16 v[44:59], a[144:147], a[120:123], v[44:59]
    v_xor_b32 v141, 131072, v141
    v_xor_b32 v145, 131072, v145
    v_lshl_add_u32 v42, v4, 11, v42
    s_lshl_b32 s22, s55, 2
    s_add_u32 s22, s22, s53
    s_lshl_b32 s22, s22, 10
    v_mfma_f32_32x32x16_bf16 v[60:75], a[144:147], a[124:127], v[60:75]
    ds_read_b64_tr_b16 a[160:161], v16 offset:4096
    ds_read_b64_tr_b16 a[162:163], v16 offset:4608
    s_sub_u32 s2, s56, s60
    s_lshl_b32 s2, s2, 6
    s_add_u32 s22, s22, s2
    s_add_u32 s22, s22, 524288
    v_mfma_f32_32x32x16_bf16 v[76:91], a[148:151], a[120:123], v[76:91]
    ds_read_b64_tr_b16 a[164:165], v17 offset:4096
    ds_read_b64_tr_b16 a[166:167], v17 offset:4608
    buffer_load_dwordx4 v10, s[24:27], s76 offen offset:2048 lds
    s_xor_b32 s3, s54, 2
    s_lshl_b32 s2, s59, 1
    v_mfma_f32_32x32x16_bf16 v[92:107], a[148:151], a[124:127], v[92:107]
    ds_read_b128 a[136:139], v141
    ds_read_b128 a[140:143], v145
    buffer_load_dwordx4 v11, s[24:27], s76 offen offset:3072 lds
    s_xor_b32 s3, s2, s3
    s_mul_i32 s2, s3, 4682
    v_mfma_f32_32x32x16_bf16 v[108:123], a[120:123], a[176:179], v[108:123]
    ds_read_b128 a[188:191], v32 offset:17408
    s_add_u32 m0, s69, 81920
    s_lshr_b32 s2, s2, 16
    s_mul_i32 s21, s2, 1490944
    s_lshl_b32 s2, s3, 13
    s_waitcnt lgkmcnt(7)
    v_mfma_f32_32x32x16_bf16 v[44:59], a[152:155], a[128:131], v[44:59]
    v_xor_b32 v18, 131072, v18
    v_xor_b32 v19, 131072, v19
    s_cmp_eq_u32 s74, s91
    s_cselect_b64 exec, -1, 0
    ds_read_b128 v[214:217], v18
    ds_read_b128 v[218:221], v19
    s_mov_b64 exec, -1
    v_mfma_f32_32x32x16_bf16 v[60:75], a[152:155], a[132:135], v[60:75]
    v_xor_b32 v142, 131072, v142
    v_xor_b32 v146, 131072, v146
    ds_read_b64_tr_b16 a[168:169], v16 offset:8192
    buffer_load_dwordx4 v12, s[28:31], s83 offen lds
    s_add_u32 s21, s21, s2
    v_mfma_f32_32x32x16_bf16 v[76:91], a[156:159], a[128:131], v[76:91]
    ds_read_b64_tr_b16 a[170:171], v16 offset:8704
    ds_read_b64_tr_b16 a[172:173], v17 offset:8192
    buffer_load_dwordx4 v13, s[28:31], s83 offen offset:1024 lds
    v_lshrrev_b32 v2, 2, s69
    s_add_u32 s21, s21, 8388608
    v_mfma_f32_32x32x16_bf16 v[92:107], a[156:159], a[132:135], v[92:107]
    ds_read_b64_tr_b16 a[174:175], v17 offset:8704
    ds_read_b128 a[144:147], v142
    s_add_u32 m0, s69, 83968
    v_add3_u32 v2, v2, s21, v1
    s_xor_b32 s3, s54, 3
    s_lshl_b32 s2, s59, 1
    v_mfma_f32_32x32x16_bf16 v[108:123], a[128:131], a[184:187], v[108:123]
    ds_read_b128 a[148:151], v146
    ds_read_b128 a[208:211], v32 offset:18432
    buffer_load_dwordx4 v14, s[32:35], s83 offen lds
    s_xor_b32 s3, s2, s3
    s_waitcnt lgkmcnt(9)
    v_mfma_f32_32x32x16_bf16 v[44:59], a[160:163], a[136:139], v[44:59]
    v_xor_b32 v143, 131072, v143
    v_xor_b32 v147, 131072, v147
    s_mul_i32 s2, s3, 4682
    s_lshr_b32 s2, s2, 16
    s_mul_i32 s21, s2, 1490944
    s_lshl_b32 s2, s3, 13
    v_mfma_f32_32x32x16_bf16 v[60:75], a[160:163], a[140:143], v[60:75]
    ds_read_b64_tr_b16 a[176:177], v16 offset:12288
    ds_read_b64_tr_b16 a[178:179], v16 offset:12800
    buffer_load_dwordx4 v15, s[32:35], s83 offen offset:1024 lds
    s_add_u32 s21, s21, s2
    v_lshrrev_b32 v3, 2, s69
    v_mfma_f32_32x32x16_bf16 v[76:91], a[164:167], a[136:139], v[76:91]
    ds_read_b64_tr_b16 a[180:181], v17 offset:12288
    ds_read_b64_tr_b16 a[182:183], v17 offset:12800
    s_add_u32 m0, s69, 147456
    s_add_u32 s21, s21, 8388608
    v_add3_u32 v3, v3, s21, v1
    s_xor_b32 s3, s54, 0
    v_mfma_f32_32x32x16_bf16 v[92:107], a[164:167], a[140:143], v[92:107]
    ds_read_b128 a[152:155], v143
    ds_read_b128 a[156:159], v147
    v_add_u32 v12, 128, v12
    v_add_u32 v13, 128, v13
    v_add_u32 v14, 128, v14
    v_add_u32 v15, 128, v15
    v_mfma_f32_32x32x16_bf16 v[108:123], a[136:139], a[188:191], v[108:123]
    ds_read_b128 a[184:187], v32 offset:19456
    buffer_load_dwordx4 v12, s[28:31], s77 offen lds
    s_lshl_b32 s2, s59, 1
    s_xor_b32 s3, s2, s3
    s_waitcnt lgkmcnt(7)
    v_mfma_f32_32x32x16_bf16 v[44:59], a[168:171], a[144:147], v[44:59]
    buffer_load_dwordx4 v13, s[28:31], s77 offen offset:1024 lds
    s_mul_i32 s2, s3, 4682
    s_lshr_b32 s2, s2, 16
    s_mul_i32 s21, s2, 1490944
    s_lshl_b32 s2, s3, 13
    v_mfma_f32_32x32x16_bf16 v[60:75], a[168:171], a[148:151], v[60:75]
    s_lshl_b32 s65, s48, 9
    s_add_u32 s65, s65, 65536
    s_xor_b32 s66, s65, 512
    v_lshlrev_b32_e64 v10, 4, v29
    buffer_load_dwordx4 v[148:151], v10, s[44:47], s65 offen sc1
    v_mfma_f32_32x32x16_bf16 v[76:91], a[172:175], a[144:147], v[76:91]
    s_waitcnt vmcnt(11) lgkmcnt(0)
    s_barrier
    ds_read_b64_tr_b16 a[192:193], v16 offset:16384
    buffer_load_dwordx4 v[152:155], v10, s[44:47], s66 offen sc1
    s_add_u32 s21, s21, s2
    v_mfma_f32_32x32x16_bf16 v[92:107], a[172:175], a[148:151], v[92:107]
    ds_read_b64_tr_b16 a[194:195], v16 offset:16896
    ds_read_b64_tr_b16 a[196:197], v17 offset:16384
    ds_read_b64_tr_b16 a[198:199], v17 offset:16896
    s_lshl_b32 s19, s56, 11
    s_add_u32 s19, s19, 262144
    v_lshlrev_b32_e64 v43, 3, v26
    v_mfma_f32_32x32x16_bf16 v[108:123], a[144:147], a[208:211], v[108:123]
    ds_read_b128 a[160:163], v140 offset:16384
    ds_read_b128 a[164:167], v144 offset:16384
    ds_read_b128 a[224:227], v32 offset:20480
    v_lshl_add_u32 v43, v28, 9, v43
    v_lshl_add_u32 v43, s54, 8, v43
    v_mfma_f32_32x32x16_bf16 v[44:59], a[176:179], a[152:155], v[44:59]
    ds_read_b64_tr_b16 a[200:201], v16 offset:20480
    ds_read_b64_tr_b16 a[202:203], v16 offset:20992
    buffer_load_dwordx2 v[188:189], v43, s[44:47], s19 offen sc1
    v_lshrrev_b32 v4, 2, s69
    s_add_u32 s21, s21, 8388608
    v_mfma_f32_32x32x16_bf16 v[60:75], a[176:179], a[156:159], v[60:75]
    ds_read_b64_tr_b16 a[204:205], v17 offset:20480
    ds_read_b64_tr_b16 a[206:207], v17 offset:20992
    buffer_load_dwordx2 v[190:191], v43, s[44:47], s19 offen offset:1024 sc1
    v_add3_u32 v4, v4, s21, v1
    s_xor_b32 s3, s54, 1
    v_mfma_f32_32x32x16_bf16 v[76:91], a[180:183], a[152:155], v[76:91]
    ds_read_b128 a[168:171], v141 offset:16384
    buffer_load_dwordx2 v[192:193], v43, s[44:47], s19 offen offset:128 sc1
    s_lshl_b32 s2, s59, 1
    s_xor_b32 s3, s2, s3
    s_mul_i32 s2, s3, 4682
    v_mfma_f32_32x32x16_bf16 v[92:107], a[180:183], a[156:159], v[92:107]
    ds_read_b128 a[172:175], v145 offset:16384
    buffer_load_dwordx2 v[194:195], v43, s[44:47], s19 offen offset:1152 sc1
    s_lshr_b32 s2, s2, 16
    s_mul_i32 s21, s2, 1490944
    s_lshl_b32 s2, s3, 13
    v_mfma_f32_32x32x16_bf16 v[108:123], a[152:155], a[184:187], v[108:123]
    ds_read_b128 a[240:243], v32 offset:21504
    s_add_u32 m0, s69, 149504
    s_add_u32 s21, s21, s2
    v_lshrrev_b32 v5, 2, s69
    s_add_u32 s21, s21, 8388608
    s_waitcnt lgkmcnt(7)
    v_mfma_f32_32x32x16_bf16 v[44:59], a[192:195], a[160:163], v[44:59]
    s_cmp_eq_u32 s75, s91
    s_cselect_b64 exec, -1, 0
    ds_read_b128 v[214:217], v18 offset:16384
    ds_read_b128 v[218:221], v19 offset:16384
    s_mov_b64 exec, -1
    v_add3_u32 v5, v5, s21, v1
    v_mfma_f32_32x32x16_bf16 v[60:75], a[192:195], a[164:167], v[60:75]
    ds_read_b64_tr_b16 a[208:209], v16 offset:24576
    ds_read_b64_tr_b16 a[210:211], v16 offset:25088
    buffer_load_dwordx4 v14, s[32:35], s77 offen lds
    v_mfma_f32_32x32x16_bf16 v[76:91], a[196:199], a[160:163], v[76:91]
    ds_read_b64_tr_b16 a[212:213], v17 offset:24576
    ds_read_b64_tr_b16 a[214:215], v17 offset:25088
    buffer_load_dwordx4 v15, s[32:35], s77 offen offset:1024 lds
    v_mfma_f32_32x32x16_bf16 v[92:107], a[196:199], a[164:167], v[92:107]
    ds_read_b128 a[176:179], v142 offset:16384
    ds_read_b128 a[180:183], v146 offset:16384
    s_add_u32 m0, s69, 49152
    v_mfma_f32_32x32x16_bf16 v[108:123], a[160:163], a[224:227], v[108:123]
    ds_read_b128 a[244:247], v32 offset:22528
    buffer_load_dwordx4 v12, s[28:31], s78 offen lds
    s_waitcnt lgkmcnt(9)
    v_mfma_f32_32x32x16_bf16 v[44:59], a[200:203], a[168:171], v[44:59]
    ds_read_b64_tr_b16 a[216:217], v16 offset:28672
    ds_read_b64_tr_b16 a[218:219], v16 offset:29184
    v_mfma_f32_32x32x16_bf16 v[60:75], a[200:203], a[172:175], v[60:75]
    ds_read_b64_tr_b16 a[220:221], v17 offset:28672
    ds_read_b64_tr_b16 a[222:223], v17 offset:29184
    buffer_load_dwordx4 v13, s[28:31], s78 offen offset:1024 lds
    v_mfma_f32_32x32x16_bf16 v[76:91], a[204:207], a[168:171], v[76:91]
    ds_read_b128 a[184:187], v143 offset:16384
    s_add_u32 m0, s69, 51200
    v_mfma_f32_32x32x16_bf16 v[92:107], a[204:207], a[172:175], v[92:107]
    ds_read_b128 a[188:191], v147 offset:16384
    buffer_load_dwordx4 v14, s[32:35], s78 offen lds
    v_mfma_f32_32x32x16_bf16 v[108:123], a[168:171], a[240:243], v[108:123]
    ds_read_b128 a[248:251], v32 offset:23552
    s_waitcnt lgkmcnt(7)
    v_mfma_f32_32x32x16_bf16 v[44:59], a[208:211], a[176:179], v[44:59]
    buffer_load_dwordx4 v15, s[32:35], s78 offen offset:1024 lds
    v_mfma_f32_32x32x16_bf16 v[60:75], a[208:211], a[180:183], v[60:75]
    v_mfma_f32_32x32x16_bf16 v[76:91], a[212:215], a[176:179], v[76:91]
    s_waitcnt vmcnt(14) lgkmcnt(0)
    s_barrier
    ds_read_b64_tr_b16 a[224:225], v16 offset:32768
    v_mfma_f32_32x32x16_bf16 v[92:107], a[212:215], a[180:183], v[92:107]
    ds_read_b64_tr_b16 a[226:227], v16 offset:33280
    ds_read_b64_tr_b16 a[228:229], v17 offset:32768
    ds_read_b64_tr_b16 a[230:231], v17 offset:33280
    v_mfma_f32_32x32x16_bf16 v[108:123], a[176:179], a[244:247], v[108:123]
    ds_read_b128 a[192:195], v140 offset:32768
    ds_read_b128 a[196:199], v144 offset:32768
    ds_read_b128 a[252:255], v32 offset:24576
    v_mfma_f32_32x32x16_bf16 v[44:59], a[216:219], a[184:187], v[44:59]
    ds_read_b64_tr_b16 a[232:233], v16 offset:36864
    ds_read_b64_tr_b16 a[234:235], v16 offset:37376
    s_add_u32 m0, s69, 65536
    v_mfma_f32_32x32x16_bf16 v[60:75], a[216:219], a[188:191], v[60:75]
    ds_read_b64_tr_b16 a[236:237], v17 offset:36864
    ds_read_b64_tr_b16 a[238:239], v17 offset:37376
    buffer_load_dwordx4 v12, s[28:31], s79 offen lds
    v_mfma_f32_32x32x16_bf16 v[76:91], a[220:223], a[184:187], v[76:91]
    ds_read_b128 a[200:203], v141 offset:32768
    buffer_load_dwordx4 v13, s[28:31], s79 offen offset:1024 lds
    v_mfma_f32_32x32x16_bf16 v[92:107], a[220:223], a[188:191], v[92:107]
    ds_read_b128 a[204:207], v145 offset:32768
    s_add_u32 m0, s69, 67584
    v_mfma_f32_32x32x16_bf16 v[108:123], a[184:187], a[248:251], v[108:123]
    ds_read_b128 v[124:127], v32 offset:25600
    buffer_load_dwordx4 v14, s[32:35], s79 offen lds
    s_waitcnt lgkmcnt(7)
    v_mfma_f32_32x32x16_bf16 v[44:59], a[224:227], a[192:195], v[44:59]
    s_cmp_eq_u32 s76, s91
    s_cselect_b64 exec, -1, 0
    ds_read_b128 v[214:217], v18 offset:32768
    ds_read_b128 v[218:221], v19 offset:32768
    s_mov_b64 exec, -1
    v_mfma_f32_32x32x16_bf16 v[60:75], a[224:227], a[196:199], v[60:75]
    ds_read_b64_tr_b16 a[240:241], v16 offset:40960
    ds_read_b64_tr_b16 a[242:243], v16 offset:41472
    buffer_load_dwordx4 v15, s[32:35], s79 offen offset:1024 lds
    v_mfma_f32_32x32x16_bf16 v[76:91], a[228:231], a[192:195], v[76:91]
    ds_read_b64_tr_b16 a[244:245], v17 offset:40960
    ds_read_b64_tr_b16 a[246:247], v17 offset:41472
    v_mfma_f32_32x32x16_bf16 v[92:107], a[228:231], a[196:199], v[92:107]
    ds_read_b128 a[208:211], v142 offset:32768
    ds_read_b128 a[212:215], v146 offset:32768
    v_mfma_f32_32x32x16_bf16 v[108:123], a[192:195], a[252:255], v[108:123]
    ds_read_b128 v[156:159], v32 offset:26624
    s_waitcnt lgkmcnt(9)
    v_mfma_f32_32x32x16_bf16 v[44:59], a[232:235], a[200:203], v[44:59]
    ds_read_b64_tr_b16 a[248:249], v16 offset:45056
    ds_read_b64_tr_b16 a[250:251], v16 offset:45568
    v_mfma_f32_32x32x16_bf16 v[60:75], a[232:235], a[204:207], v[60:75]
    ds_read_b64_tr_b16 a[252:253], v17 offset:45056
    ds_read_b64_tr_b16 a[254:255], v17 offset:45568
    v_mfma_f32_32x32x16_bf16 v[76:91], a[236:239], a[200:203], v[76:91]
    ds_read_b128 a[216:219], v143 offset:32768
    s_waitcnt vmcnt(10)
    v_and_b32 v8, v150, v154
    v_or_b32 v9, v150, v154
    v_bitop3_b32 v8, v8, v189, v191 bitop3:0x80
    v_or3_b32 v9, v9, v189, v191
    v_bitop3_b32 v8, v8, v193, v195 bitop3:0x80
    v_or3_b32 v9, v9, v193, v195
    v_xor_b32 v8, s62, v8
    v_xor_b32 v9, s62, v9
    v_or_b32_e64 v8, v8, v9
    v_cmp_eq_u32 vcc, 0, v8
    s_nop 0
    s_cmp_eq_u64 vcc, exec
    s_cbranch_scc0 L_slow0
L_ok0:
    v_mfma_f32_32x32x16_bf16 v[92:107], a[236:239], a[204:207], v[92:107]
    ds_read_b128 a[220:223], v147 offset:32768
    v_rcp_f32 v18, v149
    v_rcp_f32 v19, v153
    v_mov_b32 v160, 131072
    v_mfma_f32_32x32x16_bf16 v[108:123], a[200:203], v[124:127], v[108:123]
    ds_read_b128 v[196:199], v32 offset:27648
    v_add_u32 v160, s69, v160
    v_lshl_add_u32 v161, v29, 2, v160
    v_lshl_add_u32 v160, v27, 4, v160
    s_waitcnt lgkmcnt(7)
    v_mfma_f32_32x32x16_bf16 v[44:59], a[240:243], a[208:211], v[44:59]
    ds_write_b32 v161, v18
    v_subrev_u32 v162, 1, v27
    v_mov_b32 v223, 0
    v_mov_b32 v224, 0
    v_mov_b32 v225, 0
    v_mfma_f32_32x32x16_bf16 v[60:75], a[240:243], a[212:215], v[60:75]
    v_mov_b32 v227, 0
    v_mov_b32 v228, 0
    v_mov_b32 v229, 0
    v_and_b32 v222, v162, v148
    v_mul_f32 v8, 0xbfb8aa3b, v18
    v_mul_f32_e64 v10, v149, v149
    v_mfma_f32_32x32x16_bf16 v[76:91], a[244:247], a[208:211], v[76:91]
    s_waitcnt vmcnt(8) lgkmcnt(1)
    s_barrier
    v_and_b32_e64 v226, v162, v152
    v_mul_f32 v9, 0xbfb8aa3b, v19
    v_mul_f32 v11, v153, v153
    v_mfma_f32_32x32x16_bf16 v[92:107], a[244:247], a[212:215], v[92:107]
    ds_read_b64_tr_b16 a[224:225], v20 offset:32768
    ds_read_b64_tr_b16 a[226:227], v20 offset:33280
    s_waitcnt lgkmcnt(2)
    ds_read_b128 v[124:127], v160
    ds_read_b128 v[128:131], v160 offset:32
    ds_read_b128 v[132:135], v160 offset:64
    ds_read_b128 v[136:139], v160 offset:96
    v_mfma_f32_32x32x16_bf16 v[108:123], a[208:211], v[156:159], v[108:123]
    ds_read_b64_tr_b16 a[228:229], v21 offset:32768
    ds_read_b64_tr_b16 a[230:231], v21 offset:33280
    v_mov_b32 v205, 0
    v_mov_b32 v207, 0
    v_mov_b32_e64 v208, 0
    v_mfma_f32_32x32x16_bf16 v[44:59], a[248:251], a[216:219], v[44:59]
    ds_read_b64_tr_b16 a[232:233], v20 offset:36864
    s_add_u32 m0, s69, 81920
    v_mov_b32 v209, 0
    v_mov_b32 v210, 0
    v_mov_b32 v211, 0
    v_mov_b32 v212, 0
    v_mfma_f32_32x32x16_bf16 v[60:75], a[248:251], a[220:223], v[60:75]
    ds_read_b64_tr_b16 a[234:235], v20 offset:37376
    buffer_load_dwordx4 v12, s[28:31], s80 offen lds
    v_mov_b32 v213, 0
    v_add_f32 v188, v188, v190
    v_cvt_pk_bf16_f32 v18, v188, v188
    v_mfma_f32_32x32x16_bf16 v[76:91], a[252:255], a[216:219], v[76:91]
    ds_read_b64_tr_b16 a[236:237], v21 offset:36864
    buffer_load_dwordx4 v13, s[28:31], s80 offen offset:1024 lds
    v_lshlrev_b32 v18, 16, v18
    v_sub_f32 v190, v188, v18
    v_cvt_pk_bf16_f32 v204, v18, v190
    v_mfma_f32_32x32x16_bf16 v[92:107], a[252:255], a[220:223], v[92:107]
    ds_read_b64_tr_b16 a[238:239], v21 offset:37376
    s_add_u32 m0, s69, 83968
    v_add_f32_e64 v192, v192, v194
    v_cvt_pk_bf16_f32 v19, v192, v192
    v_lshlrev_b32 v19, 16, v19
    v_sub_f32 v194, v192, v19
    v_mfma_f32_32x32x16_bf16 v[108:123], a[216:219], v[196:199], v[108:123]
    buffer_load_dwordx4 v14, s[32:35], s80 offen lds
    v_cvt_pk_bf16_f32 v206, v19, v194
    s_waitcnt lgkmcnt(4)
    v_mfma_f32_32x32x16_bf16 v[140:155], a[224:227], a[0:3], 0
    ds_read_b64_tr_b16 a[240:241], v20 offset:40960
    s_nop 6
    v_mul_f32 v108, v108, v124
    v_mul_f32 v109, v109, v125
    v_mul_f32 v110, v110, v126
    v_mul_f32 v111, v111, v127
    v_mul_f32_e64 v112, v112, v128
    v_mfma_f32_32x32x16_bf16 v[156:171], a[224:227], a[4:7], 0
    ds_read_b64_tr_b16 a[242:243], v20 offset:41472
    buffer_load_dwordx4 v15, s[32:35], s80 offen offset:1024 lds
    v_mul_f32 v113, v113, v129
    v_mul_f32 v114, v114, v130
    v_mul_f32_e64 v115, v115, v131
    v_mfma_f32_32x32x16_bf16 v[172:187], a[228:231], a[0:3], 0
    ds_read_b64_tr_b16 a[244:245], v21 offset:40960
    s_add_u32 m0, s69, 98304
    v_mul_f32 v116, v116, v132
    v_mul_f32 v117, v117, v133
    v_mul_f32 v118, v118, v134
    v_mul_f32 v119, v119, v135
    v_mfma_f32_32x32x16_bf16 v[188:203], a[228:231], a[4:7], 0
    ds_read_b64_tr_b16 a[246:247], v21 offset:41472
    buffer_load_dwordx4 v12, s[28:31], s81 offen lds
    v_mul_f32 v120, v120, v136
    v_mul_f32 v121, v121, v137
    v_mul_f32_e64 v122, v122, v138
    v_mfma_f32_32x32x16_bf16 v[44:59], v[204:207], v[222:225], v[44:59]
    v_mul_f32_e64 v123, v123, v139
    v_cvt_pk_bf16_f32 v230, v108, v109
    v_cvt_pk_bf16_f32 v231, v110, v111
    v_cvt_pk_bf16_f32 v232, v112, v113
    v_cvt_pk_bf16_f32 v233, v114, v115
    v_cvt_pk_bf16_f32 v234, v116, v117
    v_mfma_f32_32x32x16_bf16 v[60:75], v[204:207], v[226:229], v[60:75]
    buffer_load_dwordx4 v13, s[28:31], s81 offen offset:1024 lds
    v_cvt_pk_bf16_f32 v235, v118, v119
    v_cvt_pk_bf16_f32 v236, v120, v121
    v_cvt_pk_bf16_f32 v237, v122, v123
    v_permlane16_swap_b32 v230, v234
    v_mfma_f32_32x32x16_bf16 v[76:91], v[206:209], v[222:225], v[76:91]
    s_add_u32 m0, s69, 100352
    v_permlane16_swap_b32 v231, v235
    v_permlane16_swap_b32 v232, v236
    v_permlane16_swap_b32 v233, v237
    v_mfma_f32_32x32x16_bf16 v[92:107], v[206:209], v[226:229], v[92:107]
    buffer_load_dwordx4 v14, s[32:35], s81 offen lds
    s_waitcnt lgkmcnt(4)
    v_mfma_f32_32x32x16_bf16 v[140:155], a[232:235], a[8:11], v[140:155]
    ds_read_b64_tr_b16 a[0:1], v20 offset:45056
    buffer_store_dwordx4 v[230:233], v35, s[44:47], s12 offen sc1
    v_mul_f32 v124, v44, v8
    v_mul_f32 v125, v45, v8
    v_mul_f32 v126, v46, v8
    v_mfma_f32_32x32x16_bf16 v[156:171], a[232:235], a[12:15], v[156:171]
    ds_read_b64_tr_b16 a[2:3], v20 offset:45568
    v_mul_f32 v127, v47, v8
    v_exp_f32 v124, v124
    v_exp_f32_e64 v125, v125
    v_mfma_f32_32x32x16_bf16 v[172:187], a[236:239], a[8:11], v[172:187]
    ds_read_b64_tr_b16 a[4:5], v21 offset:45056
    buffer_store_dwordx4 v[234:237], v35, s[44:47], s12 offen offset:1024 sc1
    v_exp_f32_e64 v126, v126
    v_mfma_f32_32x32x16_bf16 v[188:203], a[236:239], a[12:15], v[188:203]
    ds_read_b64_tr_b16 a[6:7], v21 offset:45568
    v_exp_f32 v127, v127
    v_mul_f32 v44, v44, v52
    v_mul_f32 v45, v45, v53
    s_waitcnt lgkmcnt(4)
    v_mfma_f32_32x32x16_bf16 v[140:155], a[240:243], a[16:19], v[140:155]
    buffer_load_dwordx4 v15, s[32:35], s81 offen offset:1024 lds
    v_mul_f32 v46, v46, v54
    v_mul_f32 v47, v47, v55
    v_fma_f32 v124, v124, v10, v10
    v_fma_f32 v125, v125, v10, v10
    v_mfma_f32_32x32x16_bf16 v[156:171], a[240:243], a[20:23], v[156:171]
    s_waitcnt vmcnt(14) lgkmcnt(0)
    s_barrier
    s_add_u32 m0, s69, 114688
    v_fma_f32 v126, v126, v10, v10
    v_fma_f32 v127, v127, v10, v10
    v_mfma_f32_32x32x16_bf16 v[172:187], a[244:247], a[16:19], v[172:187]
    ds_read_b64_tr_b16 a[224:225], v16
    ds_read_b64_tr_b16 a[226:227], v16 offset:512
    buffer_load_dwordx4 v12, s[28:31], s82 offen lds
    v_rcp_f32_e64 v124, v124
    v_mfma_f32_32x32x16_bf16 v[188:203], a[244:247], a[20:23], v[188:203]
    ds_read_b64_tr_b16 a[228:229], v17
    ds_read_b64_tr_b16 a[230:231], v17 offset:512
    v_rcp_f32_e64 v125, v125
    v_mfma_f32_32x32x16_bf16 v[140:155], a[0:3], a[24:27], v[140:155]
    ds_read_b64_tr_b16 a[8:9], v16 offset:4096
    buffer_load_dwordx4 v13, s[28:31], s82 offen offset:1024 lds
    v_rcp_f32_e64 v126, v126
    v_mfma_f32_32x32x16_bf16 v[156:171], a[0:3], a[28:31], v[156:171]
    ds_read_b64_tr_b16 a[10:11], v16 offset:4608
    s_add_u32 m0, s69, 116736
    v_rcp_f32 v127, v127
    v_mul_f32 v44, v44, v124
    v_mul_f32_e64 v45, v45, v125
    v_mfma_f32_32x32x16_bf16 v[172:187], a[4:7], a[24:27], v[172:187]
    ds_read_b64_tr_b16 a[12:13], v17 offset:4096
    buffer_load_dwordx4 v14, s[32:35], s82 offen lds
    v_mul_f32 v46, v46, v126
    v_mul_f32 v47, v47, v127
    v_cvt_pk_bf16_f32 v108, v44, v45
    v_mfma_f32_32x32x16_bf16 v[188:203], a[4:7], a[28:31], v[188:203]
    ds_read_b64_tr_b16 a[14:15], v17 offset:4608
    v_cvt_pk_bf16_f32 v109, v46, v47
    v_mul_f32 v112, v48, v8
    v_mul_f32 v113, v49, v8
    v_mul_f32 v114, v50, v8
    s_waitcnt lgkmcnt(4)
    v_mfma_f32_32x32x16_bf16 v[140:155], a[224:227], a[32:35], v[140:155]
    ds_read_b64_tr_b16 a[16:17], v16 offset:8192
    buffer_load_dwordx4 v15, s[32:35], s82 offen offset:1024 lds
    v_mul_f32 v115, v51, v8
    v_exp_f32 v112, v112
    v_mfma_f32_32x32x16_bf16 v[156:171], a[224:227], a[36:39], v[156:171]
    ds_read_b64_tr_b16 a[18:19], v16 offset:8704
    s_add_u32 m0, s69, 147456
    v_exp_f32 v113, v113
    v_exp_f32 v114, v114
    v_mfma_f32_32x32x16_bf16 v[172:187], a[228:231], a[32:35], v[172:187]
    ds_read_b64_tr_b16 a[20:21], v17 offset:8192
    buffer_load_dwordx4 v12, s[28:31], s83 offen lds
    v_exp_f32 v115, v115
    v_mul_f32 v48, v48, v56
    v_mfma_f32_32x32x16_bf16 v[188:203], a[228:231], a[36:39], v[188:203]
    ds_read_b64_tr_b16 a[22:23], v17 offset:8704
    v_mul_f32 v49, v49, v57
    v_mul_f32 v50, v50, v58
    v_mul_f32 v51, v51, v59
    v_fma_f32 v112, v112, v10, v10
    s_waitcnt lgkmcnt(4)
    v_mfma_f32_32x32x16_bf16 v[140:155], a[8:11], a[40:43], v[140:155]
    ds_read_b64_tr_b16 a[0:1], v16 offset:12288
    buffer_load_dwordx4 v13, s[28:31], s83 offen offset:1024 lds
    v_fma_f32 v113, v113, v10, v10
    v_fma_f32 v114, v114, v10, v10
    v_fma_f32 v115, v115, v10, v10
    v_mfma_f32_32x32x16_bf16 v[156:171], a[8:11], a[44:47], v[156:171]
    ds_read_b64_tr_b16 a[2:3], v16 offset:12800
    s_add_u32 m0, s69, 149504
    v_rcp_f32 v112, v112
    v_rcp_f32 v113, v113
    v_mfma_f32_32x32x16_bf16 v[172:187], a[12:15], a[40:43], v[172:187]
    ds_read_b64_tr_b16 a[4:5], v17 offset:12288
    buffer_load_dwordx4 v14, s[32:35], s83 offen lds
    v_rcp_f32_e64 v114, v114
    v_mfma_f32_32x32x16_bf16 v[188:203], a[12:15], a[44:47], v[188:203]
    ds_read_b64_tr_b16 a[6:7], v17 offset:12800
    v_rcp_f32 v115, v115
    v_mul_f32 v48, v48, v112
    v_mul_f32 v49, v49, v113
    s_waitcnt lgkmcnt(4)
    v_mfma_f32_32x32x16_bf16 v[140:155], a[16:19], a[48:51], v[140:155]
    buffer_load_dwordx4 v15, s[32:35], s83 offen offset:1024 lds
    v_mul_f32 v50, v50, v114
    v_mul_f32 v51, v51, v115
    v_cvt_pk_bf16_f32 v110, v48, v49
    v_cvt_pk_bf16_f32 v111, v50, v51
    v_mfma_f32_32x32x16_bf16 v[156:171], a[16:19], a[52:55], v[156:171]
    s_waitcnt vmcnt(18) lgkmcnt(0)
    s_barrier
    s_add_u32 m0, s69, 0
    v_mul_f32 v116, v60, v9
    v_mul_f32 v117, v61, v9
    v_mul_f32 v118, v62, v9
    v_mfma_f32_32x32x16_bf16 v[172:187], a[20:23], a[48:51], v[172:187]
    ds_read_b64_tr_b16 a[24:25], v16 offset:16384
    ds_read_b64_tr_b16 a[26:27], v16 offset:16896
    buffer_load_dwordx4 v6, s[36:39], s4 offen lds
    v_mul_f32_e64 v119, v63, v9
    v_mfma_f32_32x32x16_bf16 v[188:203], a[20:23], a[52:55], v[188:203]
    ds_read_b64_tr_b16 a[28:29], v17 offset:16384
    ds_read_b64_tr_b16 a[30:31], v17 offset:16896
    buffer_load_dwordx4 v7, s[36:39], s4 offen offset:1024 lds
    v_mfma_f32_32x32x16_bf16 v[140:155], a[0:3], a[56:59], v[140:155]
    ds_read_b64_tr_b16 a[8:9], v16 offset:20480
    s_add_u32 m0, s69, 2048
    v_exp_f32 v116, v116
    v_exp_f32 v117, v117
    v_mfma_f32_32x32x16_bf16 v[156:171], a[0:3], a[60:63], v[156:171]
    ds_read_b64_tr_b16 a[10:11], v16 offset:20992
    v_exp_f32 v118, v118
    v_exp_f32 v119, v119
    v_mul_f32_e64 v60, v60, v68
    v_mfma_f32_32x32x16_bf16 v[172:187], a[4:7], a[56:59], v[172:187]
    ds_read_b64_tr_b16 a[12:13], v17 offset:20480
    buffer_load_dwordx4 v6, s[36:39], s5 offen lds
    v_mul_f32 v61, v61, v69
    v_mul_f32 v62, v62, v70
    v_mul_f32 v63, v63, v71
    v_mfma_f32_32x32x16_bf16 v[188:203], a[4:7], a[60:63], v[188:203]
    ds_read_b64_tr_b16 a[14:15], v17 offset:20992
    buffer_load_dwordx4 v7, s[36:39], s5 offen offset:1024 lds
    v_fma_f32 v116, v116, v11, v11
    v_fma_f32 v117, v117, v11, v11
    s_waitcnt lgkmcnt(4)
    v_mfma_f32_32x32x16_bf16 v[140:155], a[24:27], a[64:67], v[140:155]
    ds_read_b64_tr_b16 a[16:17], v16 offset:24576
    s_add_u32 m0, s69, 16384
    v_fma_f32 v118, v118, v11, v11
    v_fma_f32 v119, v119, v11, v11
    v_rcp_f32_e64 v116, v116
    v_mfma_f32_32x32x16_bf16 v[156:171], a[24:27], a[68:71], v[156:171]
    ds_read_b64_tr_b16 a[18:19], v16 offset:25088
    buffer_load_dwordx4 v6, s[36:39], s6 offen lds
    v_rcp_f32_e64 v117, v117
    v_mfma_f32_32x32x16_bf16 v[172:187], a[28:31], a[64:67], v[172:187]
    ds_read_b64_tr_b16 a[20:21], v17 offset:24576
    v_rcp_f32 v118, v118
    v_rcp_f32 v119, v119
    v_mul_f32_e64 v60, v60, v116
    v_mfma_f32_32x32x16_bf16 v[188:203], a[28:31], a[68:71], v[188:203]
    ds_read_b64_tr_b16 a[22:23], v17 offset:25088
    buffer_load_dwordx4 v7, s[36:39], s6 offen offset:1024 lds
    v_mul_f32_e64 v61, v61, v117
    v_mul_f32 v62, v62, v118
    s_waitcnt lgkmcnt(4)
    v_mfma_f32_32x32x16_bf16 v[140:155], a[8:11], a[72:75], v[140:155]
    ds_read_b64_tr_b16 a[0:1], v16 offset:28672
    s_add_u32 m0, s69, 18432
    v_mul_f32_e64 v63, v63, v119
    v_cvt_pk_bf16_f32 v12, v60, v61
    v_cvt_pk_bf16_f32 v13, v62, v63
    v_mul_f32_e64 v44, v64, v9
    v_mfma_f32_32x32x16_bf16 v[156:171], a[8:11], a[76:79], v[156:171]
    ds_read_b64_tr_b16 a[2:3], v16 offset:29184
    buffer_load_dwordx4 v6, s[36:39], s7 offen lds
    v_mul_f32 v45, v65, v9
    v_mul_f32 v46, v66, v9
    v_mul_f32_e64 v47, v67, v9
    v_mfma_f32_32x32x16_bf16 v[172:187], a[12:15], a[72:75], v[172:187]
    ds_read_b64_tr_b16 a[4:5], v17 offset:28672
    v_exp_f32 v44, v44
    v_exp_f32 v45, v45
    v_mfma_f32_32x32x16_bf16 v[188:203], a[12:15], a[76:79], v[188:203]
    ds_read_b64_tr_b16 a[6:7], v17 offset:29184
    buffer_load_dwordx4 v7, s[36:39], s7 offen offset:1024 lds
    v_exp_f32 v46, v46
    s_waitcnt lgkmcnt(4)
    v_mfma_f32_32x32x16_bf16 v[140:155], a[16:19], a[80:83], v[140:155]
    s_add_u32 m0, s69, 32768
    v_exp_f32 v47, v47
    v_mul_f32 v64, v64, v72
    v_mul_f32 v65, v65, v73
    v_mul_f32 v66, v66, v74
    v_mfma_f32_32x32x16_bf16 v[156:171], a[16:19], a[84:87], v[156:171]
    s_waitcnt vmcnt(22) lgkmcnt(0)
    s_barrier
    buffer_load_dwordx4 v6, s[36:39], s8 offen lds
    v_mul_f32 v67, v67, v75
    v_fma_f32 v44, v44, v11, v11
    v_mfma_f32_32x32x16_bf16 v[172:187], a[20:23], a[80:83], v[172:187]
    ds_read_b64_tr_b16 a[24:25], v16 offset:32768
    ds_read_b64_tr_b16 a[26:27], v16 offset:33280
    s_waitcnt vmcnt(18)
    buffer_store_dword v34, v33, s[44:47], s84 offen sc1
    v_fma_f32 v45, v45, v11, v11
    v_fma_f32 v46, v46, v11, v11
    v_mfma_f32_32x32x16_bf16 v[188:203], a[20:23], a[84:87], v[188:203]
    ds_read_b64_tr_b16 a[28:29], v17 offset:32768
    ds_read_b64_tr_b16 a[30:31], v17 offset:33280
    buffer_load_dwordx4 v7, s[36:39], s8 offen offset:1024 lds
    v_fma_f32 v47, v47, v11, v11
    v_mfma_f32_32x32x16_bf16 v[140:155], a[0:3], a[88:91], v[140:155]
    ds_read_b64_tr_b16 a[8:9], v16 offset:36864
    s_add_u32 m0, s69, 34816
    v_rcp_f32 v44, v44
    v_rcp_f32 v45, v45
    v_mfma_f32_32x32x16_bf16 v[156:171], a[0:3], a[92:95], v[156:171]
    ds_read_b64_tr_b16 a[10:11], v16 offset:37376
    v_rcp_f32 v46, v46
    v_rcp_f32 v47, v47
    v_mul_f32_e64 v64, v64, v44
    v_mfma_f32_32x32x16_bf16 v[172:187], a[4:7], a[88:91], v[172:187]
    ds_read_b64_tr_b16 a[12:13], v17 offset:36864
    buffer_load_dwordx4 v6, s[36:39], s9 offen lds
    v_mul_f32 v65, v65, v45
    v_mul_f32 v66, v66, v46
    v_mul_f32_e64 v67, v67, v47
    v_mfma_f32_32x32x16_bf16 v[188:203], a[4:7], a[92:95], v[188:203]
    ds_read_b64_tr_b16 a[14:15], v17 offset:37376
    buffer_load_dwordx4 v7, s[36:39], s9 offen offset:1024 lds
    v_cvt_pk_bf16_f32 v14, v64, v65
    v_cvt_pk_bf16_f32 v15, v66, v67
    s_waitcnt lgkmcnt(4)
    v_mfma_f32_32x32x16_bf16 v[140:155], a[24:27], a[96:99], v[140:155]
    ds_read_b64_tr_b16 a[16:17], v16 offset:40960
    s_add_u32 m0, s69, 131072
    v_mul_f32 v48, v76, v8
    v_mul_f32 v49, v77, v8
    v_mul_f32 v50, v78, v8
    v_mul_f32_e64 v51, v79, v8
    v_mfma_f32_32x32x16_bf16 v[156:171], a[24:27], a[100:103], v[156:171]
    ds_read_b64_tr_b16 a[18:19], v16 offset:41472
    buffer_load_dwordx4 v6, s[36:39], s10 offen lds
    v_exp_f32_e64 v48, v48
    v_mfma_f32_32x32x16_bf16 v[172:187], a[28:31], a[96:99], v[172:187]
    ds_read_b64_tr_b16 a[20:21], v17 offset:40960
    v_exp_f32 v49, v49
    v_exp_f32 v50, v50
    v_mfma_f32_32x32x16_bf16 v[188:203], a[28:31], a[100:103], v[188:203]
    ds_read_b64_tr_b16 a[22:23], v17 offset:41472
    buffer_load_dwordx4 v7, s[36:39], s10 offen offset:1024 lds
    v_exp_f32 v51, v51
    s_waitcnt lgkmcnt(4)
    v_mfma_f32_32x32x16_bf16 v[140:155], a[8:11], a[104:107], v[140:155]
    ds_read_b64_tr_b16 a[0:1], v16 offset:45056
    s_add_u32 m0, s69, 133120
    v_mul_f32 v76, v76, v84
    v_mul_f32 v77, v77, v85
    v_mul_f32 v78, v78, v86
    v_mul_f32 v79, v79, v87
    v_mfma_f32_32x32x16_bf16 v[156:171], a[8:11], a[108:111], v[156:171]
    ds_read_b64_tr_b16 a[2:3], v16 offset:45568
    v_add_u32 v6, 57344, v6
    v_add_u32 v7, 57344, v7
    buffer_load_dwordx4 v6, s[36:39], s4 offen lds
    v_fma_f32 v48, v48, v10, v10
    v_mfma_f32_32x32x16_bf16 v[172:187], a[12:15], a[104:107], v[172:187]
    ds_read_b64_tr_b16 a[4:5], v17 offset:45056
    v_fma_f32 v49, v49, v10, v10
    v_fma_f32 v50, v50, v10, v10
    v_fma_f32 v51, v51, v10, v10
    v_rcp_f32_e64 v48, v48
    v_mfma_f32_32x32x16_bf16 v[188:203], a[12:15], a[108:111], v[188:203]
    ds_read_b64_tr_b16 a[6:7], v17 offset:45568
    buffer_load_dwordx4 v7, s[36:39], s4 offen offset:1024 lds
    v_rcp_f32 v49, v49
    s_waitcnt lgkmcnt(4)
    v_mfma_f32_32x32x16_bf16 v[140:155], a[16:19], a[112:115], v[140:155]
    s_add_u32 m0, s69, 49152
    v_rcp_f32 v50, v50
    v_rcp_f32 v51, v51
    v_mul_f32_e64 v76, v76, v48
    v_mfma_f32_32x32x16_bf16 v[156:171], a[16:19], a[116:119], v[156:171]
    s_waitcnt vmcnt(25) lgkmcnt(0)
    s_barrier
    buffer_load_dwordx4 v6, s[36:39], s5 offen lds
    v_mul_f32 v77, v77, v49
    v_mul_f32 v78, v78, v50
    v_mfma_f32_32x32x16_bf16 v[172:187], a[20:23], a[112:115], v[172:187]
    ds_read_b64_tr_b16 a[24:25], v16 offset:49152
    ds_read_b64_tr_b16 a[26:27], v16 offset:49664
    v_mul_f32_e64 v79, v79, v51
    v_cvt_pk_bf16_f32 v52, v76, v77
    v_cvt_pk_bf16_f32 v53, v78, v79
    v_mul_f32_e64 v56, v80, v8
    v_mfma_f32_32x32x16_bf16 v[188:203], a[20:23], a[116:119], v[188:203]
    ds_read_b64_tr_b16 a[28:29], v17 offset:49152
    ds_read_b64_tr_b16 a[30:31], v17 offset:49664
    buffer_load_dwordx4 v7, s[36:39], s5 offen offset:1024 lds
    v_mul_f32_e64 v57, v81, v8
    v_mfma_f32_32x32x16_bf16 v[140:155], a[0:3], a[120:123], v[140:155]
    ds_read_b64_tr_b16 a[8:9], v16 offset:53248
    s_add_u32 m0, s69, 51200
    v_mul_f32 v58, v82, v8
    v_mul_f32 v59, v83, v8
    v_exp_f32_e64 v56, v56
    v_mfma_f32_32x32x16_bf16 v[156:171], a[0:3], a[124:127], v[156:171]
    ds_read_b64_tr_b16 a[10:11], v16 offset:53760
    buffer_load_dwordx4 v6, s[36:39], s6 offen lds
    v_exp_f32_e64 v57, v57
    v_mfma_f32_32x32x16_bf16 v[172:187], a[4:7], a[120:123], v[172:187]
    ds_read_b64_tr_b16 a[12:13], v17 offset:53248
    v_exp_f32 v58, v58
    v_exp_f32 v59, v59
    v_mul_f32_e64 v80, v80, v88
    v_mfma_f32_32x32x16_bf16 v[188:203], a[4:7], a[124:127], v[188:203]
    ds_read_b64_tr_b16 a[14:15], v17 offset:53760
    buffer_load_dwordx4 v7, s[36:39], s6 offen offset:1024 lds
    v_mul_f32_e64 v81, v81, v89
    v_mul_f32 v82, v82, v90
    s_waitcnt lgkmcnt(4)
    v_mfma_f32_32x32x16_bf16 v[140:155], a[24:27], a[128:131], v[140:155]
    ds_read_b64_tr_b16 a[16:17], v16 offset:57344
    s_add_u32 m0, s69, 65536
    v_mul_f32_e64 v83, v83, v91
    v_fma_f32 v56, v56, v10, v10
    v_fma_f32 v57, v57, v10, v10
    v_fma_f32 v58, v58, v10, v10
    v_mfma_f32_32x32x16_bf16 v[156:171], a[24:27], a[132:135], v[156:171]
    ds_read_b64_tr_b16 a[18:19], v16 offset:57856
    buffer_load_dwordx2 v[44:45], v43, s[44:47], s86 offen sc1
    v_fma_f32 v59, v59, v10, v10
    v_rcp_f32_e64 v56, v56
    v_mfma_f32_32x32x16_bf16 v[172:187], a[28:31], a[128:131], v[172:187]
    ds_read_b64_tr_b16 a[20:21], v17 offset:57344
    buffer_load_dwordx2 v[46:47], v43, s[44:47], s86 offen offset:1024 sc1
    v_rcp_f32_e64 v57, v57
    v_mfma_f32_32x32x16_bf16 v[188:203], a[28:31], a[132:135], v[188:203]
    ds_read_b64_tr_b16 a[22:23], v17 offset:57856
    buffer_load_dwordx2 v[48:49], v43, s[44:47], s86 offen offset:128 sc1
    v_rcp_f32 v58, v58
    s_waitcnt lgkmcnt(4)
    v_mfma_f32_32x32x16_bf16 v[140:155], a[8:11], a[136:139], v[140:155]
    ds_read_b64_tr_b16 a[0:1], v16 offset:61440
    buffer_load_dwordx2 v[50:51], v43, s[44:47], s86 offen offset:1152 sc1
    v_rcp_f32 v59, v59
    v_mul_f32 v80, v80, v56
    v_mfma_f32_32x32x16_bf16 v[156:171], a[8:11], a[140:143], v[156:171]
    ds_read_b64_tr_b16 a[2:3], v16 offset:61952
    buffer_load_dwordx4 v6, s[36:39], s7 offen lds
    v_mul_f32 v81, v81, v57
    v_mul_f32 v82, v82, v58
    v_mul_f32_e64 v83, v83, v59
    v_mfma_f32_32x32x16_bf16 v[172:187], a[12:15], a[136:139], v[172:187]
    ds_read_b64_tr_b16 a[4:5], v17 offset:61440
    buffer_load_dwordx4 v7, s[36:39], s7 offen offset:1024 lds
    v_cvt_pk_bf16_f32 v54, v80, v81
    v_cvt_pk_bf16_f32 v55, v82, v83
    v_mul_f32_e64 v60, v92, v9
    v_mfma_f32_32x32x16_bf16 v[188:203], a[12:15], a[140:143], v[188:203]
    ds_read_b64_tr_b16 a[6:7], v17 offset:61952
    s_add_u32 m0, s69, 67584
    v_mul_f32 v61, v93, v9
    v_mul_f32 v62, v94, v9
    v_mul_f32 v63, v95, v9
    s_waitcnt lgkmcnt(4)
    v_mfma_f32_32x32x16_bf16 v[140:155], a[16:19], a[144:147], v[140:155]
    v_exp_f32 v60, v60
    v_exp_f32 v61, v61
    v_exp_f32_e64 v62, v62
    v_mfma_f32_32x32x16_bf16 v[156:171], a[16:19], a[148:151], v[156:171]
    s_waitcnt vmcnt(31) lgkmcnt(0)
    s_barrier
    s_mov_b32 s90, 22528
    buffer_load_dword v32, v40, s[44:47], s90 offen sc1
    v_mfma_f32_32x32x16_bf16 v[172:187], a[20:23], a[144:147], v[172:187]
    ds_read_b64_tr_b16 a[24:25], v20
    ds_read_b64_tr_b16 a[26:27], v20 offset:512
    buffer_store_dwordx4 v[108:111], v1, s[44:47], s14 offen sc1
    v_exp_f32_e64 v63, v63
    v_mfma_f32_32x32x16_bf16 v[188:203], a[20:23], a[148:151], v[188:203]
    ds_read_b64_tr_b16 a[28:29], v21
    ds_read_b64_tr_b16 a[30:31], v21 offset:512
    buffer_load_dwordx4 v6, s[36:39], s8 offen lds
    v_mul_f32_e64 v92, v92, v100
    v_mfma_f32_32x32x16_bf16 v[140:155], a[0:3], a[152:155], v[140:155]
    ds_read_b64_tr_b16 a[8:9], v20 offset:4096
    v_mul_f32 v93, v93, v101
    v_mul_f32 v94, v94, v102
    v_mul_f32_e64 v95, v95, v103
    v_fma_f32 v60, v60, v11, v11
    v_fma_f32 v61, v61, v11, v11
    v_mfma_f32_32x32x16_bf16 v[156:171], a[0:3], a[156:159], v[156:171]
    ds_read_b64_tr_b16 a[10:11], v20 offset:4608
    buffer_load_dwordx4 v7, s[36:39], s8 offen offset:1024 lds
    v_fma_f32 v62, v62, v11, v11
    v_fma_f32 v63, v63, v11, v11
    v_mfma_f32_32x32x16_bf16 v[172:187], a[4:7], a[152:155], v[172:187]
    ds_read_b64_tr_b16 a[12:13], v21 offset:4096
    s_add_u32 m0, s69, 81920
    v_rcp_f32 v60, v60
    v_rcp_f32 v61, v61
    v_mfma_f32_32x32x16_bf16 v[188:203], a[4:7], a[156:159], v[188:203]
    ds_read_b64_tr_b16 a[14:15], v21 offset:4608
    buffer_load_dwordx4 v6, s[36:39], s9 offen lds
    v_rcp_f32 v62, v62
    s_waitcnt lgkmcnt(4)
    v_mfma_f32_32x32x16_bf16 v[140:155], a[24:27], a[160:163], v[140:155]
    ds_read_b64_tr_b16 a[16:17], v20 offset:8192
    v_rcp_f32 v63, v63
    v_mul_f32 v92, v92, v60
    v_mul_f32 v93, v93, v61
    v_mul_f32 v94, v94, v62
    v_mfma_f32_32x32x16_bf16 v[156:171], a[24:27], a[164:167], v[156:171]
    ds_read_b64_tr_b16 a[18:19], v20 offset:8704
    buffer_store_dwordx4 v[12:15], v1, s[44:47], s15 offen sc1
    v_mul_f32_e64 v95, v95, v63
    v_cvt_pk_bf16_f32 v16, v92, v93
    v_cvt_pk_bf16_f32 v17, v94, v95
    v_mfma_f32_32x32x16_bf16 v[172:187], a[28:31], a[160:163], v[172:187]
    ds_read_b64_tr_b16 a[20:21], v21 offset:8192
    v_mul_f32 v56, v96, v9
    v_mul_f32 v57, v97, v9
    v_mul_f32 v58, v98, v9
    v_mul_f32 v59, v99, v9
    v_mfma_f32_32x32x16_bf16 v[188:203], a[28:31], a[164:167], v[188:203]
    ds_read_b64_tr_b16 a[22:23], v21 offset:8704
    buffer_load_dwordx4 v7, s[36:39], s9 offen offset:1024 lds
    v_exp_f32 v56, v56
    s_waitcnt lgkmcnt(4)
    v_mfma_f32_32x32x16_bf16 v[140:155], a[8:11], a[168:171], v[140:155]
    ds_read_b64_tr_b16 a[32:33], v20 offset:12288
    s_add_u32 m0, s69, 83968
    v_exp_f32 v57, v57
    v_exp_f32 v58, v58
    v_mfma_f32_32x32x16_bf16 v[156:171], a[8:11], a[172:175], v[156:171]
    ds_read_b64_tr_b16 a[34:35], v20 offset:12800
    buffer_load_dwordx4 v6, s[36:39], s10 offen lds
    v_exp_f32 v59, v59
    v_mul_f32 v96, v96, v104
    v_mfma_f32_32x32x16_bf16 v[172:187], a[12:15], a[168:171], v[172:187]
    ds_read_b64_tr_b16 a[36:37], v21 offset:12288
    v_mul_f32 v97, v97, v105
    v_mul_f32 v98, v98, v106
    v_mul_f32_e64 v99, v99, v107
    v_fma_f32 v56, v56, v11, v11
    v_fma_f32 v57, v57, v11, v11
    v_mfma_f32_32x32x16_bf16 v[188:203], a[12:15], a[172:175], v[188:203]
    ds_read_b64_tr_b16 a[38:39], v21 offset:12800
    v_fma_f32 v58, v58, v11, v11
    v_fma_f32 v59, v59, v11, v11
    v_rcp_f32 v56, v56
    s_waitcnt lgkmcnt(4)
    v_mfma_f32_32x32x16_bf16 v[140:155], a[16:19], a[176:179], v[140:155]
    v_rcp_f32 v57, v57
    v_rcp_f32 v58, v58
    v_rcp_f32_e64 v59, v59
    v_mfma_f32_32x32x16_bf16 v[156:171], a[16:19], a[180:183], v[156:171]
    s_waitcnt vmcnt(35) lgkmcnt(0)
    s_barrier
    buffer_store_dwordx4 v[52:55], v1, s[44:47], s14 offen offset:1024 sc1
    v_mul_f32 v96, v96, v56
    v_mul_f32 v97, v97, v57
    v_mfma_f32_32x32x16_bf16 v[172:187], a[20:23], a[176:179], v[172:187]
    ds_read_b64_tr_b16 a[40:41], v20 offset:32768
    ds_read_b64_tr_b16 a[42:43], v20 offset:33280
    buffer_load_dwordx4 v7, s[36:39], s10 offen offset:1024 lds
    v_mul_f32 v98, v98, v58
    v_mul_f32 v99, v99, v59
    v_mfma_f32_32x32x16_bf16 v[188:203], a[20:23], a[180:183], v[188:203]
    ds_read_b64_tr_b16 a[44:45], v21 offset:32768
    ds_read_b64_tr_b16 a[46:47], v21 offset:33280
    v_cvt_pk_bf16_f32 v18, v96, v97
    v_cvt_pk_bf16_f32 v19, v98, v99
    v_mfma_f32_32x32x16_bf16 v[140:155], a[32:35], a[184:187], v[140:155]
    ds_read_b64_tr_b16 a[64:65], v20 offset:36864
    s_waitcnt vmcnt(35)
    ds_read_b64_tr_b16 a[0:1], v22
    ds_read_b64_tr_b16 a[2:3], v22 offset:1024
    ds_read_b64_tr_b16 a[4:5], v23
    ds_read_b64_tr_b16 a[6:7], v23 offset:1024
    v_lshlrev_b32 v12, 2, v25
    v_mfma_f32_32x32x16_bf16 v[156:171], a[32:35], a[188:191], v[156:171]
    ds_read_b64_tr_b16 a[66:67], v20 offset:37376
    buffer_load_dword v13, v38, s[44:47], s49 offen sc1
    s_waitcnt vmcnt(34)
    ds_read_b64_tr_b16 a[8:9], v22 offset:2048
    ds_read_b64_tr_b16 a[10:11], v22 offset:3072
    v_cvt_f32_u32 v12, v12
    v_mfma_f32_32x32x16_bf16 v[172:187], a[36:39], a[184:187], v[172:187]
    ds_read_b64_tr_b16 a[68:69], v21 offset:36864
    ds_read_b64_tr_b16 a[12:13], v23 offset:2048
    ds_read_b64_tr_b16 a[14:15], v23 offset:3072
    v_cvt_f32_u32 v6, v26
    s_lshl_b32 s2, s52, 4
    v_cvt_f32_u32 v7, s2
    v_mfma_f32_32x32x16_bf16 v[188:203], a[36:39], a[188:191], v[188:203]
    ds_read_b64_tr_b16 a[70:71], v21 offset:37376
    s_waitcnt vmcnt(32)
    ds_read_b64_tr_b16 a[16:17], v22 offset:16384
    ds_read_b64_tr_b16 a[18:19], v22 offset:17408
    ds_read_b64_tr_b16 a[20:21], v23 offset:16384
    v_add_f32 v7, v7, v6
    s_waitcnt lgkmcnt(15)
    v_mfma_f32_32x32x16_bf16 v[140:155], a[40:43], a[192:195], v[140:155]
    ds_read_b64_tr_b16 a[80:81], v20 offset:40960
    buffer_store_dwordx4 v[16:19], v1, s[44:47], s15 offen offset:1024 sc1
    ds_read_b64_tr_b16 a[22:23], v23 offset:17408
    s_waitcnt vmcnt(14)
    v_and_b32 v14, v45, v47
    v_or_b32_e64 v15, v45, v47
    v_bitop3_b32 v14, v14, v49, v51 bitop3:0x80
    v_or3_b32 v15, v15, v49, v51
    v_xor_b32 v14, s62, v14
    v_xor_b32 v15, s62, v15
    v_or_b32_e64 v14, v14, v15
    v_cmp_eq_u32 vcc, 0, v14
    s_nop 0
    s_cmp_eq_u64 vcc, exec
    s_cbranch_scc0 L_slow1
L_ok1:
    v_mfma_f32_32x32x16_bf16 v[156:171], a[40:43], a[196:199], v[156:171]
    ds_read_b64_tr_b16 a[82:83], v20 offset:41472
    v_add_f32_e64 v44, v44, v46
    v_cvt_pk_bf16_f32 v35, v44, v44
    v_lshlrev_b32 v35, 16, v35
    v_sub_f32 v46, v44, v35
    v_cvt_pk_bf16_f32 v208, v35, v46
    v_mfma_f32_32x32x16_bf16 v[172:187], a[44:47], a[192:195], v[172:187]
    ds_read_b64_tr_b16 a[84:85], v21 offset:40960
    v_add_f32_e64 v48, v48, v50
    v_cvt_pk_bf16_f32 v60, v48, v48
    v_lshlrev_b32 v60, 16, v60
    v_sub_f32 v50, v48, v60
    v_cvt_pk_bf16_f32 v210, v60, v50
    v_mfma_f32_32x32x16_bf16 v[188:203], a[44:47], a[196:199], v[188:203]
    ds_read_b64_tr_b16 a[86:87], v21 offset:41472
    ds_read_b64_tr_b16 a[24:25], v22 offset:18432
    ds_read_b64_tr_b16 a[26:27], v22 offset:19456
    ds_read_b64_tr_b16 a[28:29], v23 offset:18432
    v_mul_f32 v59, 0x3a000000, v7
    s_waitcnt lgkmcnt(11)
    v_mfma_f32_32x32x16_bf16 v[140:155], a[64:67], a[200:203], v[140:155]
    ds_read_b64_tr_b16 a[96:97], v20 offset:45056
    ds_read_b64_tr_b16 a[30:31], v23 offset:19456
    v_mul_f32 v7, 0x3c800000, v7
    v_mul_f32 v14, v12, v7
    v_add_f32_e64 v15, v14, v7
    v_fma_f32 v16, 2.0, v7, v14
    v_mfma_f32_32x32x16_bf16 v[156:171], a[64:67], a[204:207], v[156:171]
    ds_read_b64_tr_b16 a[98:99], v20 offset:45568
    ds_read_b64_tr_b16 a[32:33], v22 offset:32768
    ds_read_b64_tr_b16 a[34:35], v22 offset:33792
    ds_read_b64_tr_b16 a[36:37], v23 offset:32768
    ds_read_b64_tr_b16 a[38:39], v23 offset:33792
    v_fma_f32 v17, 2.0, v7, v15
    v_mfma_f32_32x32x16_bf16 v[172:187], a[68:71], a[200:203], v[172:187]
    ds_read_b64_tr_b16 a[100:101], v21 offset:45056
    ds_read_b64_tr_b16 a[40:41], v22 offset:34816
    ds_read_b64_tr_b16 a[42:43], v22 offset:35840
    ds_read_b64_tr_b16 a[44:45], v23 offset:34816
    ds_read_b64_tr_b16 a[46:47], v23 offset:35840
    v_mfma_f32_32x32x16_bf16 v[188:203], a[68:71], a[204:207], v[188:203]
    ds_read_b64_tr_b16 a[102:103], v21 offset:45568
    v_add_u32 v22, 131072, v22
    v_add_u32 v23, 131072, v23
    s_waitcnt vmcnt(11)
    v_cmp_eq_u32 vcc, s62, v32
    s_nop 0
    s_cmp_eq_u64 vcc, exec
    s_cbranch_scc0 L_slow2
L_ok2:
    s_waitcnt lgkmcnt(15)
    v_mfma_f32_32x32x16_bf16 v[140:155], a[80:83], a[208:211], v[140:155]
    buffer_load_dwordx4 v[44:47], v41, s[44:47], s87 offen sc1
    ds_read_b64_tr_b16 a[48:49], v22
    ds_read_b64_tr_b16 a[50:51], v22 offset:1024
    ds_read_b64_tr_b16 a[52:53], v23
    v_mfma_f32_32x32x16_bf16 v[156:171], a[80:83], a[212:215], v[156:171]
    buffer_load_dwordx4 v[48:51], v41, s[44:47], s87 offen offset:64 sc1
    ds_read_b64_tr_b16 a[54:55], v23 offset:1024
    v_cos_f32_e64 v60, v14
    v_mfma_f32_32x32x16_bf16 v[172:187], a[84:87], a[208:211], v[172:187]
    ds_read_b64_tr_b16 a[56:57], v22 offset:2048
    ds_read_b64_tr_b16 a[58:59], v22 offset:3072
    ds_read_b64_tr_b16 a[60:61], v23 offset:2048
    ds_read_b64_tr_b16 a[62:63], v23 offset:3072
    v_sin_f32_e64 v64, v14
    v_mfma_f32_32x32x16_bf16 v[188:203], a[84:87], a[212:215], v[188:203]
    v_subrev_u32 v22, 131072, v22
    v_subrev_u32 v23, 131072, v23
    v_cos_f32 v61, v15
    s_waitcnt lgkmcnt(8)
    v_mfma_f32_32x32x16_bf16 v[140:155], a[96:99], a[216:219], v[140:155]
    ds_read_b64_tr_b16 a[64:65], v22 offset:49152
    ds_read_b64_tr_b16 a[66:67], v22 offset:50176
    ds_read_b64_tr_b16 a[68:69], v23 offset:49152
    ds_read_b64_tr_b16 a[70:71], v23 offset:50176
    v_sin_f32_e64 v65, v15
    v_mfma_f32_32x32x16_bf16 v[156:171], a[96:99], a[220:223], v[156:171]
    ds_read_b64_tr_b16 a[72:73], v22 offset:51200
    ds_read_b64_tr_b16 a[74:75], v22 offset:52224
    ds_read_b64_tr_b16 a[76:77], v23 offset:51200
    ds_read_b64_tr_b16 a[78:79], v23 offset:52224
    v_cos_f32_e64 v62, v16
    v_mfma_f32_32x32x16_bf16 v[172:187], a[100:103], a[216:219], v[172:187]
    v_add_u32 v22, 65536, v22
    v_add_u32 v23, 65536, v23
    v_sin_f32 v66, v16
    v_cos_f32 v63, v17
    v_mfma_f32_32x32x16_bf16 v[188:203], a[100:103], a[220:223], v[188:203]
    ds_read_b64_tr_b16 a[80:81], v22
    ds_read_b64_tr_b16 a[82:83], v22 offset:1024
    ds_read_b64_tr_b16 a[84:85], v23
    ds_read_b64_tr_b16 a[86:87], v23 offset:1024
    v_mfma_f32_32x32x16_bf16 v[140:155], v[208:211], v[222:225], v[140:155]
    s_waitcnt vmcnt(10)
    ds_read_b64_tr_b16 a[88:89], v22 offset:2048
    ds_read_b64_tr_b16 a[90:91], v22 offset:3072
    ds_read_b64_tr_b16 a[92:93], v23 offset:2048
    ds_read_b64_tr_b16 a[94:95], v23 offset:3072
    v_sin_f32 v67, v17
    v_mfma_f32_32x32x16_bf16 v[156:171], v[208:211], v[226:229], v[156:171]
    v_cvt_pk_bf16_f32 v70, v60, v61
    v_cvt_pk_bf16_f32 v71, v62, v63
    v_cvt_pk_bf16_f32 v72, v64, v65
    v_cvt_pk_bf16_f32 v73, v66, v67
    v_xor_b32 v68, 0x80008000, v72
    v_xor_b32 v69, 0x80008000, v73
    v_mfma_f32_32x32x16_bf16 v[172:187], v[210:213], v[222:225], v[172:187]
    v_bfe_i32 v32, v26, 0, 1
    v_bfe_i32 v35, v26, 1, 1
    v_xor_b32 v41, v32, v35
    v_and_b32 v35, 0x80008000, v35
    v_and_b32 v41, 0x80008000, v41
    v_bfi_b32 v43, v32, v72, v70
    v_mfma_f32_32x32x16_bf16 v[188:203], v[210:213], v[226:229], v[188:203]
    s_waitcnt vmcnt(7)
    ds_read_b64_tr_b16 a[96:97], v22 offset:16384
    ds_read_b64_tr_b16 a[98:99], v22 offset:17408
    ds_read_b64_tr_b16 a[100:101], v23 offset:16384
    ds_read_b64_tr_b16 a[102:103], v23 offset:17408
    v_bfi_b32 v92, v32, v70, v72
    v_xor_b32 v76, v41, v43
    v_mul_f32 v18, v140, v8
    v_mul_f32 v19, v141, v8
    v_mul_f32 v20, v142, v8
    v_mul_f32 v21, v143, v8
    v_exp_f32 v18, v18
    v_exp_f32 v19, v19
    v_exp_f32 v20, v20
    v_exp_f32 v21, v21
    v_mul_f32 v140, v140, v148
    v_mul_f32 v141, v141, v149
    v_mul_f32 v142, v142, v150
    v_mul_f32_e64 v143, v143, v151
    v_fma_f32 v18, v18, v10, v10
    v_fma_f32 v19, v19, v10, v10
    v_fma_f32 v20, v20, v10, v10
    v_fma_f32 v21, v21, v10, v10
    v_rcp_f32 v18, v18
    v_rcp_f32 v19, v19
    v_rcp_f32 v20, v20
    v_rcp_f32 v21, v21
    v_mul_f32 v140, v140, v18
    v_mul_f32 v141, v141, v19
    v_mul_f32 v142, v142, v20
    v_mul_f32 v143, v143, v21
    v_cvt_pk_bf16_f32 v14, v140, v141
    v_cvt_pk_bf16_f32 v15, v142, v143
    v_mul_f32 v60, v144, v8
    v_mul_f32 v61, v145, v8
    v_mul_f32 v62, v146, v8
    v_mul_f32 v63, v147, v8
    v_exp_f32 v60, v60
    v_exp_f32 v61, v61
    v_exp_f32 v62, v62
    v_exp_f32 v63, v63
    v_mul_f32 v144, v144, v152
    v_mul_f32 v145, v145, v153
    v_mul_f32 v146, v146, v154
    v_mul_f32 v147, v147, v155
    v_fma_f32 v60, v60, v10, v10
    v_fma_f32 v61, v61, v10, v10
    v_fma_f32 v62, v62, v10, v10
    v_fma_f32 v63, v63, v10, v10
    s_waitcnt vmcnt(3)
    v_cmp_eq_u32 vcc, s62, v13
    s_nop 0
    s_cmp_eq_u64 vcc, exec
    s_cbranch_scc0 L_slow3
L_ok3:
    v_rcp_f32 v60, v60
    s_add_u32 m0, s13, 106496
    v_rcp_f32_e64 v61, v61
    buffer_load_dwordx4 v39, s[44:47], s88 offen sc1 lds
    v_rcp_f32_e64 v62, v62
    s_add_u32 s88, s88, 15360
    buffer_load_dwordx4 v39, s[44:47], s88 offen offset:1024 sc1 lds
    v_rcp_f32 v63, v63
    v_mul_f32 v144, v144, v60
    v_mul_f32 v145, v145, v61
    v_mul_f32 v146, v146, v62
    v_mul_f32_e64 v147, v147, v63
    v_cvt_pk_bf16_f32 v16, v144, v145
    v_cvt_pk_bf16_f32 v17, v146, v147
    v_mul_f32 v18, v156, v9
    v_mul_f32 v19, v157, v9
    v_mul_f32_e64 v20, v158, v9
    s_add_u32 s14, s14, 4096
    buffer_store_dwordx4 v[14:17], v1, s[44:47], s14 offen sc1
    v_mul_f32 v21, v159, v9
    v_exp_f32 v18, v18
    v_exp_f32 v19, v19
    v_exp_f32 v20, v20
    v_exp_f32 v21, v21
    v_mul_f32 v156, v156, v164
    v_mul_f32 v157, v157, v165
    v_mul_f32 v158, v158, v166
    v_mul_f32_e64 v159, v159, v167
    v_fma_f32 v18, v18, v11, v11
    v_fma_f32 v19, v19, v11, v11
    v_fma_f32 v20, v20, v11, v11
    v_fma_f32 v21, v21, v11, v11
    v_rcp_f32 v18, v18
    v_rcp_f32 v19, v19
    v_rcp_f32 v20, v20
    v_rcp_f32 v21, v21
    v_mul_f32 v156, v156, v18
    v_mul_f32 v157, v157, v19
    v_mul_f32 v158, v158, v20
    v_mul_f32 v159, v159, v21
    v_cvt_pk_bf16_f32 v60, v156, v157
    v_cvt_pk_bf16_f32 v61, v158, v159
    v_mul_f32 v14, v160, v9
    v_mul_f32 v15, v161, v9
    v_mul_f32 v16, v162, v9
    v_mul_f32 v17, v163, v9
    v_exp_f32 v14, v14
    v_exp_f32 v15, v15
    v_exp_f32 v16, v16
    v_exp_f32 v17, v17
    v_mul_f32 v160, v160, v168
    v_mul_f32 v161, v161, v169
    ds_read_b64_tr_b16 a[104:105], v22 offset:18432
    ds_read_b64_tr_b16 a[106:107], v22 offset:19456
    ds_read_b64_tr_b16 a[108:109], v23 offset:18432
    ds_read_b64_tr_b16 a[110:111], v23 offset:19456
    v_mul_f32 v162, v162, v170
    v_mul_f32 v163, v163, v171
    v_fma_f32 v14, v14, v11, v11
    v_fma_f32 v15, v15, v11, v11
    v_fma_f32 v16, v16, v11, v11
    v_fma_f32 v17, v17, v11, v11
    v_rcp_f32 v14, v14
    v_rcp_f32 v15, v15
    v_rcp_f32 v16, v16
    v_rcp_f32 v17, v17
    v_mul_f32 v160, v160, v14
    v_mul_f32 v161, v161, v15
    v_mul_f32 v162, v162, v16
    v_mul_f32 v163, v163, v17
    v_cvt_pk_bf16_f32 v62, v160, v161
    v_cvt_pk_bf16_f32 v63, v162, v163
    s_add_u32 s15, s15, 4096
    buffer_store_dwordx4 v[60:63], v1, s[44:47], s15 offen sc1
    v_mul_f32_e64 v18, v172, v8
    s_mov_b32 s51, 24576
    buffer_load_dword v7, v40, s[44:47], s51 offen sc1
    v_mul_f32 v19, v173, v8
    s_waitcnt vmcnt(7)
    buffer_store_dword v34, v33, s[44:47], s16 offen sc1
    s_add_u32 s16, s16, 131072
    v_mul_f32 v20, v174, v8
    v_mul_f32 v21, v175, v8
    v_exp_f32 v18, v18
    v_exp_f32 v19, v19
    v_exp_f32 v20, v20
    v_exp_f32 v21, v21
    v_mul_f32 v172, v172, v180
    v_mul_f32 v173, v173, v181
    v_mul_f32 v174, v174, v182
    v_mul_f32 v175, v175, v183
    v_fma_f32 v18, v18, v10, v10
    v_fma_f32 v19, v19, v10, v10
    v_fma_f32 v20, v20, v10, v10
    v_fma_f32 v21, v21, v10, v10
    v_rcp_f32 v18, v18
    v_rcp_f32 v19, v19
    v_rcp_f32 v20, v20
    v_rcp_f32 v21, v21
    v_mul_f32 v172, v172, v18
    v_mul_f32 v173, v173, v19
    v_mul_f32 v174, v174, v20
    v_mul_f32 v175, v175, v21
    v_cvt_pk_bf16_f32 v14, v172, v173
    v_cvt_pk_bf16_f32 v15, v174, v175
    v_mul_f32 v60, v176, v8
    v_mul_f32 v61, v177, v8
    v_mul_f32 v62, v178, v8
    v_mul_f32 v63, v179, v8
    v_exp_f32 v60, v60
    v_exp_f32 v61, v61
    v_exp_f32 v62, v62
    v_exp_f32 v63, v63
    v_mul_f32 v176, v176, v184
    v_mul_f32 v177, v177, v185
    v_mul_f32 v178, v178, v186
    v_mul_f32 v179, v179, v187
    v_fma_f32 v60, v60, v10, v10
    v_fma_f32 v61, v61, v10, v10
    v_fma_f32 v62, v62, v10, v10
    v_fma_f32 v63, v63, v10, v10
    v_rcp_f32 v60, v60
    v_rcp_f32 v61, v61
    v_rcp_f32 v62, v62
    v_rcp_f32 v63, v63
    v_mul_f32 v176, v176, v60
    v_mul_f32 v177, v177, v61
    v_mul_f32 v178, v178, v62
    v_mul_f32 v179, v179, v63
    v_cvt_pk_bf16_f32 v16, v176, v177
    v_cvt_pk_bf16_f32 v17, v178, v179
    buffer_store_dwordx4 v[14:17], v1, s[44:47], s14 offen offset:1024 sc1
    v_mul_f32 v18, v188, v9
    v_mul_f32 v19, v189, v9
    v_mul_f32 v20, v190, v9
    v_mul_f32 v21, v191, v9
    v_exp_f32 v18, v18
    v_exp_f32 v19, v19
    v_exp_f32 v20, v20
    v_exp_f32 v21, v21
    v_mul_f32 v188, v188, v196
    v_mul_f32 v189, v189, v197
    v_mul_f32 v190, v190, v198
    v_mul_f32 v191, v191, v199
    v_fma_f32 v18, v18, v11, v11
    v_fma_f32 v19, v19, v11, v11
    v_fma_f32 v20, v20, v11, v11
    v_fma_f32 v21, v21, v11, v11
    v_rcp_f32 v18, v18
    v_rcp_f32 v19, v19
    v_rcp_f32 v20, v20
    v_rcp_f32 v21, v21
    v_mul_f32 v188, v188, v18
    v_mul_f32 v189, v189, v19
    v_mul_f32 v190, v190, v20
    v_mul_f32 v191, v191, v21
    v_cvt_pk_bf16_f32 v14, v188, v189
    v_cvt_pk_bf16_f32 v15, v190, v191
    v_mul_f32 v60, v192, v9
    v_mul_f32 v61, v193, v9
    v_mul_f32 v62, v194, v9
    v_mul_f32 v63, v195, v9
    v_exp_f32 v60, v60
    v_exp_f32 v61, v61
    v_exp_f32 v62, v62
    v_exp_f32 v63, v63
    v_mul_f32 v192, v192, v200
    v_mul_f32 v193, v193, v201
    v_mul_f32 v194, v194, v202
    v_mul_f32 v195, v195, v203
    v_fma_f32 v60, v60, v11, v11
    v_fma_f32 v61, v61, v11, v11
    v_fma_f32 v62, v62, v11, v11
    v_fma_f32 v63, v63, v11, v11
    v_rcp_f32 v60, v60
    v_rcp_f32 v61, v61
    v_rcp_f32 v62, v62
    v_rcp_f32 v63, v63
    v_mul_f32 v192, v192, v60
    v_mul_f32 v193, v193, v61
    v_mul_f32 v194, v194, v62
    v_mul_f32 v195, v195, v63
    v_cvt_pk_bf16_f32 v16, v192, v193
    v_cvt_pk_bf16_f32 v17, v194, v195
    buffer_store_dwordx4 v[14:17], v1, s[44:47], s15 offen offset:1024 sc1
    v_xor_b32 v78, v35, v92
    v_xor_b32 v82, v35, v43
    v_xor_b32_e64 v84, v41, v92
    v_xor_b32 v74, 0x80008000, v78
    v_xor_b32 v80, 0x80008000, v84
    v_bfi_b32 v13, v32, v73, v71
    v_bfi_b32 v18, v32, v71, v73
    v_xor_b32 v77, v41, v13
    v_xor_b32 v79, v35, v18
    v_xor_b32 v83, v35, v13
    v_xor_b32 v85, v41, v18
    v_xor_b32 v75, 0x80008000, v79
    v_xor_b32 v81, 0x80008000, v85
    v_and_b32 v32, 0x80008000, v32
    v_xor_b32 v86, v32, v68
    v_xor_b32 v87, v32, v69
    v_xor_b32 v88, v32, v70
    v_xor_b32 v89, v32, v71
    v_xor_b32 v90, v32, v72
    v_xor_b32 v91, v32, v73
    v_lshl_add_u32 v19, v25, 2, v30
    v_lshlrev_b32 v19, 7, v19
    v_lshrrev_b32 v14, 1, v31
    v_lshl_add_u32 v19, v14, 3, v19
    v_add_u32 v19, 106496, v19
    v_and_b32 v14, 1, v31
    v_lshlrev_b32 v14, 1, v14
    v_lshl_add_u32 v14, v28, 2, v14
    v_lshrrev_b32 v15, 1, v30
    v_add_u32 v14, v14, v15
    v_lshl_add_u32 v8, v14, 4, v19
    v_xor_b32 v9, 16, v8
    v_xor_b32 v10, 64, v8
    v_xor_b32 v11, 80, v8
    s_waitcnt vmcnt(6)
    s_barrier
    ds_read_b64_tr_b16 v[60:61], v8
    ds_read_b64_tr_b16 v[62:63], v10
    ds_read_b64_tr_b16 v[64:65], v8 offset:2048
    ds_read_b64_tr_b16 v[66:67], v10 offset:2048
    ds_read_b64_tr_b16 v[92:93], v8 offset:4096
    ds_read_b64_tr_b16 v[94:95], v10 offset:4096
    ds_read_b64_tr_b16 v[96:97], v8 offset:6144
    ds_read_b64_tr_b16 v[98:99], v10 offset:6144
    ds_read_b64_tr_b16 v[100:101], v9
    ds_read_b64_tr_b16 v[102:103], v11
    ds_read_b64_tr_b16 v[104:105], v9 offset:2048
    ds_read_b64_tr_b16 v[106:107], v11 offset:2048
    ds_read_b64_tr_b16 v[108:109], v9 offset:4096
    ds_read_b64_tr_b16 v[110:111], v11 offset:4096
    ds_read_b64_tr_b16 v[112:113], v9 offset:6144
    ds_read_b64_tr_b16 v[114:115], v11 offset:6144
    s_mul_i32 s21, s52, 14336
    v_mov_b32 v13, v59
    v_mul_f32 v22, v12, v13
    v_fmamk_f32 v23, v13, 0x41800000, v22
    v_cos_f32 v25, v13
    v_sin_f32 v26, v13
    v_cos_f32 v52, v22
    v_sin_f32 v14, v22
    v_mul_f32 v53, v52, v25
    v_mul_f32 v15, v14, v25
    v_fma_f32 v53, -v14, v26, v53
    v_fma_f32 v15, v52, v26, v15
    s_waitcnt lgkmcnt(14)
    v_mfma_f32_16x16x32_bf16 v[116:119], v[60:63], v[70:73], 0
    v_mul_f32 v54, v53, v25
    v_mul_f32_e64 v16, v15, v25
    v_mfma_f32_16x16x32_bf16 v[120:123], v[60:63], v[68:71], 0
    v_fma_f32 v54, -v15, v26, v54
    v_fma_f32 v16, v53, v26, v16
    s_waitcnt lgkmcnt(12)
    v_mfma_f32_16x16x32_bf16 v[116:119], v[64:67], v[76:79], v[116:119]
    v_mul_f32 v55, v54, v25
    v_mul_f32_e64 v17, v16, v25
    v_mfma_f32_16x16x32_bf16 v[120:123], v[64:67], v[74:77], v[120:123]
    v_fma_f32 v55, -v16, v26, v55
    v_fma_f32 v17, v54, v26, v17
    s_waitcnt lgkmcnt(10)
    v_mfma_f32_16x16x32_bf16 v[116:119], v[92:95], v[88:91], v[116:119]
    v_cos_f32 v56, v23
    v_mfma_f32_16x16x32_bf16 v[120:123], v[92:95], v[86:89], v[120:123]
    v_sin_f32 v18, v23
    s_waitcnt lgkmcnt(8)
    v_mfma_f32_16x16x32_bf16 v[116:119], v[96:99], v[82:85], v[116:119]
    v_mul_f32 v57, v56, v25
    v_mul_f32 v19, v18, v25
    v_mfma_f32_16x16x32_bf16 v[120:123], v[96:99], v[80:83], v[120:123]
    v_fma_f32 v57, -v18, v26, v57
    v_fma_f32 v19, v56, v26, v19
    s_waitcnt lgkmcnt(6)
    v_mfma_f32_16x16x32_bf16 v[8:11], v[100:103], v[70:73], 0
    v_mul_f32 v58, v57, v25
    v_mul_f32_e64 v20, v19, v25
    v_mfma_f32_16x16x32_bf16 v[124:127], v[100:103], v[68:71], 0
    v_fma_f32 v58, -v19, v26, v58
    v_fma_f32 v20, v57, v26, v20
    s_waitcnt lgkmcnt(4)
    v_mfma_f32_16x16x32_bf16 v[8:11], v[104:107], v[76:79], v[8:11]
    v_mul_f32 v59, v58, v25
    v_mul_f32_e64 v21, v20, v25
    v_mfma_f32_16x16x32_bf16 v[124:127], v[104:107], v[74:77], v[124:127]
    v_fma_f32 v59, -v20, v26, v59
    v_fma_f32 v21, v58, v26, v21
    s_waitcnt lgkmcnt(2)
    v_mfma_f32_16x16x32_bf16 v[8:11], v[108:111], v[88:91], v[8:11]
    v_mul_f32 v13, 0x3d000000, v6
    v_mul_f32 v60, v12, v13
    v_mfma_f32_16x16x32_bf16 v[124:127], v[108:111], v[86:89], v[124:127]
    v_add_f32 v61, v60, v13
    v_fma_f32 v62, 2.0, v13, v60
    s_waitcnt lgkmcnt(0)
    v_mfma_f32_16x16x32_bf16 v[8:11], v[112:115], v[82:85], v[8:11]
    v_fma_f32 v63, 2.0, v13, v61
    v_mfma_f32_16x16x32_bf16 v[124:127], v[112:115], v[80:83], v[124:127]
    v_cos_f32 v64, v60
    v_sin_f32 v128, v60
    v_cos_f32 v65, v61
    v_sin_f32 v129, v61
    v_cos_f32 v66, v62
    v_sin_f32 v130, v62
    v_cos_f32 v67, v63
    v_sin_f32 v131, v63
    v_cvt_pk_bf16_f32 v94, v64, v65
    v_cvt_pk_bf16_f32 v95, v66, v67
    v_cvt_pk_bf16_f32 v96, v128, v129
    v_cvt_pk_bf16_f32 v97, v130, v131
    v_xor_b32 v92, 0x80008000, v96
    v_xor_b32 v93, 0x80008000, v97
    v_xor_b32 v98, v32, v92
    v_xor_b32 v99, v32, v93
    v_xor_b32 v100, v32, v94
    v_xor_b32 v101, v32, v95
    v_xor_b32 v102, v32, v96
    v_xor_b32 v103, v32, v97
    v_xor_b32 v104, 0x80000000, v92
    v_xor_b32 v105, 0x80000000, v93
    v_xor_b32 v106, 0x80000000, v94
    v_xor_b32 v107, 0x80000000, v95
    v_xor_b32 v108, 0x80000000, v96
    buffer_load_dword v13, v42, s[44:47], s22 offen sc1
    v_xor_b32 v109, 0x80000000, v97
    v_xor_b32 v110, 0x80000000, v98
    v_xor_b32 v111, 0x80000000, v99
    v_xor_b32 v112, 0x80000000, v100
    v_xor_b32 v113, 0x80000000, v101
    v_xor_b32 v114, 0x80000000, v102
    v_xor_b32 v115, 0x80000000, v103
    v_mul_f32 v60, v116, v52
    v_mul_f32 v64, v120, v52
    v_fma_f32 v60, v120, v14, v60
    v_fma_f32 v64, -v116, v14, v64
    v_mul_f32 v61, v117, v53
    v_mul_f32 v65, v121, v53
    v_fma_f32 v61, v121, v15, v61
    v_fma_f32 v65, -v117, v15, v65
    v_mul_f32 v62, v118, v54
    v_mul_f32 v66, v122, v54
    v_fma_f32 v62, v122, v16, v62
    v_fma_f32 v66, -v118, v16, v66
    v_mul_f32 v63, v119, v55
    v_mul_f32 v67, v123, v55
    v_fma_f32 v63, v123, v17, v63
    v_fma_f32 v67, -v119, v17, v67
    v_cvt_pk_bf16_f32 v128, v60, v61
    v_cvt_pk_bf16_f32 v129, v62, v63
    v_cvt_pk_bf16_f32 v130, v64, v65
    v_cvt_pk_bf16_f32 v131, v66, v67
    v_mul_f32 v132, v8, v56
    v_mul_f32 v136, v124, v56
    v_fma_f32 v132, v124, v18, v132
    v_fma_f32 v136, -v8, v18, v136
    v_mul_f32 v133, v9, v57
    v_mul_f32 v137, v125, v57
    v_fma_f32 v133, v125, v19, v133
    v_fma_f32 v137, -v9, v19, v137
    v_mul_f32 v134, v10, v58
    v_mul_f32 v138, v126, v58
    v_fma_f32 v134, v126, v20, v134
    v_fma_f32 v138, -v10, v20, v138
    v_mul_f32 v135, v11, v59
    v_mul_f32 v139, v127, v59
    v_fma_f32 v135, v127, v21, v135
    v_fma_f32 v139, -v11, v21, v139
    v_cvt_pk_bf16_f32 v140, v132, v133
    v_cvt_pk_bf16_f32 v141, v134, v135
    v_cvt_pk_bf16_f32 v142, v136, v137
    v_cvt_pk_bf16_f32 v143, v138, v139
    v_mfma_f32_16x16x32_bf16 v[116:119], v[94:97], v[128:131], 0
    s_lshl_b32 s2, s52, 4
    v_cvt_f32_u32 v22, s2
    v_mfma_f32_16x16x32_bf16 v[120:123], v[92:95], v[128:131], 0
    v_add_f32_e64 v22, v22, v12
    v_mul_f32 v23, 0x3a000000, v6
    v_mfma_f32_16x16x32_bf16 v[116:119], v[100:103], v[140:143], v[116:119]
    v_add_f32 v25, 0x3c000000, v23
    v_mul_f32_e64 v26, v22, v23
    v_mfma_f32_16x16x32_bf16 v[120:123], v[98:101], v[140:143], v[120:123]
    v_mul_f32_e64 v32, v22, v25
    v_mfma_f32_16x16x32_bf16 v[144:147], v[106:109], v[128:131], 0
    v_cos_f32_e64 v35, v23
    v_mfma_f32_16x16x32_bf16 v[148:151], v[104:107], v[128:131], 0
    v_sin_f32_e64 v38, v23
    v_mfma_f32_16x16x32_bf16 v[144:147], v[112:115], v[140:143], v[144:147]
    v_cos_f32_e64 v60, v26
    v_mfma_f32_16x16x32_bf16 v[148:151], v[110:113], v[140:143], v[148:151]
    v_sin_f32 v52, v26
    v_lshlrev_b32 v8, 16, v44
    v_and_b32 v14, 0xffff0000, v44
    v_lshlrev_b32_e64 v9, 16, v45
    v_and_b32 v15, 0xffff0000, v45
    v_lshlrev_b32_e64 v10, 16, v46
    v_and_b32 v16, 0xffff0000, v46
    v_lshlrev_b32_e64 v11, 16, v47
    v_and_b32 v17, 0xffff0000, v47
    v_mul_f32 v18, v116, v8
    v_mul_f32 v124, v120, v8
    v_fma_f32 v18, -v120, v14, v18
    v_fma_f32 v124, v116, v14, v124
    v_mul_f32 v19, v117, v9
    v_mul_f32 v125, v121, v9
    v_fma_f32 v19, -v121, v15, v19
    v_fma_f32 v125, v117, v15, v125
    v_mul_f32 v20, v118, v10
    v_mul_f32 v126, v122, v10
    v_fma_f32 v20, -v122, v16, v20
    v_fma_f32 v126, v118, v16, v126
    v_mul_f32 v21, v119, v11
    v_mul_f32 v127, v123, v11
    v_fma_f32 v21, -v123, v17, v21
    v_fma_f32 v127, v119, v17, v127
    v_cvt_pk_bf16_f32 v128, v124, v125
    v_cvt_pk_bf16_f32 v129, v126, v127
    v_cvt_pk_bf16_f32 v130, v18, v19
    v_cvt_pk_bf16_f32 v131, v20, v21
    v_lshlrev_b32_e64 v132, 16, v48
    v_and_b32 v136, 0xffff0000, v48
    v_lshlrev_b32 v133, 16, v49
    v_and_b32 v137, 0xffff0000, v49
    s_waitcnt vmcnt(1)
    buffer_store_dword v34, v33, s[44:47], s16 offen sc1
    s_add_u32 s16, s16, 131072
    v_lshlrev_b32_e64 v134, 16, v50
    v_and_b32 v138, 0xffff0000, v50
    v_lshlrev_b32_e64 v135, 16, v51
    v_and_b32 v139, 0xffff0000, v51
    v_mul_f32 v140, v144, v132
    v_mul_f32 v152, v148, v132
    v_fma_f32 v140, -v148, v136, v140
    v_fma_f32 v152, v144, v136, v152
    v_mul_f32 v141, v145, v133
    v_mul_f32 v153, v149, v133
    v_fma_f32 v141, -v149, v137, v141
    v_fma_f32 v153, v145, v137, v153
    v_mul_f32 v142, v146, v134
    v_mul_f32 v154, v150, v134
    v_fma_f32 v142, -v150, v138, v142
    v_fma_f32 v154, v146, v138, v154
    v_mul_f32 v143, v147, v135
    v_mul_f32 v155, v151, v135
    v_fma_f32 v143, -v151, v139, v143
    v_fma_f32 v155, v147, v139, v155
    v_cvt_pk_bf16_f32 v8, v152, v153
    v_cvt_pk_bf16_f32 v9, v154, v155
    v_cvt_pk_bf16_f32 v10, v140, v141
    v_cvt_pk_bf16_f32 v11, v142, v143
    v_mfma_f32_16x16x32_bf16 v[14:17], v[128:131], v[92:95], 0
    v_mul_f32 v60, 0x36124925, v60
    v_mul_f32 v52, 0x36124925, v52
    v_mfma_f32_16x16x32_bf16 v[18:21], v[128:131], v[94:97], 0
    v_mul_f32 v61, v60, v35
    v_mul_f32 v53, v52, v35
    v_mfma_f32_16x16x32_bf16 v[14:17], v[8:11], v[98:101], v[14:17]
    v_fma_f32 v61, -v52, v38, v61
    v_fma_f32 v53, v60, v38, v53
    v_mfma_f32_16x16x32_bf16 v[18:21], v[8:11], v[100:103], v[18:21]
    v_mul_f32 v62, v61, v35
    v_mul_f32 v54, v53, v35
    v_mfma_f32_16x16x32_bf16 v[44:47], v[128:131], v[104:107], 0
    v_fma_f32 v62, -v53, v38, v62
    v_fma_f32 v54, v61, v38, v54
    v_mfma_f32_16x16x32_bf16 v[48:51], v[128:131], v[106:109], 0
    v_mul_f32 v63, v62, v35
    v_mul_f32 v55, v54, v35
    v_mfma_f32_16x16x32_bf16 v[44:47], v[8:11], v[110:113], v[44:47]
    v_fma_f32 v63, -v54, v38, v63
    v_fma_f32 v55, v62, v38, v55
    v_mfma_f32_16x16x32_bf16 v[48:51], v[8:11], v[112:115], v[48:51]
    v_cos_f32 v6, v25
    v_sin_f32 v12, v25
    v_cos_f32 v64, v32
    v_sin_f32 v56, v32
    v_mul_f32 v64, 0x36124925, v64
    v_mul_f32 v56, 0x36124925, v56
    v_mul_f32 v65, v64, v6
    v_mul_f32 v57, v56, v6
    v_fma_f32 v65, -v56, v12, v65
    v_fma_f32 v57, v64, v12, v57
    v_mul_f32 v66, v65, v6
    v_mul_f32 v58, v57, v6
    v_fma_f32 v66, -v57, v12, v66
    v_fma_f32 v58, v65, v12, v58
    v_mul_f32 v67, v66, v6
    v_mul_f32 v59, v58, v6
    v_fma_f32 v67, -v58, v12, v67
    v_fma_f32 v59, v66, v12, v59
    v_lshrrev_b32 v26, 1, s69
    v_add_u32 v35, 122880, v1
    v_add_u32 v26, v26, v35
    v_mul_f32 v92, v14, v60
    v_mul_f32_e64 v8, v18, v60
    v_fma_f32 v92, -v18, v52, v92
    v_fma_f32 v8, v14, v52, v8
    v_mul_f32 v93, v15, v61
    v_mul_f32 v9, v19, v61
    v_fma_f32 v93, -v19, v53, v93
    v_fma_f32 v9, v15, v53, v9
    v_mul_f32 v94, v16, v62
    v_mul_f32 v10, v20, v62
    v_fma_f32 v94, -v20, v54, v94
    v_fma_f32 v10, v16, v54, v10
    v_mul_f32 v95, v17, v63
    v_mul_f32 v11, v21, v63
    v_fma_f32 v95, -v21, v55, v95
    v_fma_f32 v11, v17, v55, v11
    v_cvt_pk_bf16_f32 v96, v8, v9
    v_cvt_pk_bf16_f32 v97, v10, v11
    v_cvt_pk_bf16_f32 v98, v92, v93
    v_cvt_pk_bf16_f32 v99, v94, v95
    ds_write_b128 v26, v[96:99]
    v_cmp_eq_u32 vcc, s62, v7
    s_nop 0
    s_cmp_eq_u64 vcc, exec
    s_cbranch_scc0 L_slow4
L_ok4:
    v_mul_f32_e64 v100, v44, v64
    v_mul_f32 v104, v48, v64
    v_fma_f32 v100, -v48, v56, v100
    s_waitcnt vmcnt(1)
    v_cmp_eq_u32 vcc, s62, v13
    s_nop 0
    s_cmp_eq_u64 vcc, exec
    s_cbranch_scc0 L_slow5
L_ok5:
    v_fma_f32 v104, v44, v56, v104
    buffer_load_dwordx4 a[112:115], v2, s[44:47], s4 offen sc1
    v_mul_f32_e64 v101, v45, v65
    buffer_load_dwordx4 a[116:119], v3, s[44:47], s4 offen sc1
    v_mul_f32_e64 v105, v49, v65
    v_fma_f32 v101, -v49, v57, v101
    v_fma_f32 v105, v45, v57, v105
    v_mul_f32 v102, v46, v66
    v_mul_f32 v106, v50, v66
    v_fma_f32 v102, -v50, v58, v102
    v_fma_f32 v106, v46, v58, v106
    v_mul_f32 v103, v47, v67
    v_mul_f32 v107, v51, v67
    v_fma_f32 v103, -v51, v59, v103
    v_fma_f32 v107, v47, v59, v107
    v_cvt_pk_bf16_f32 v6, v104, v105
    v_cvt_pk_bf16_f32 v7, v106, v107
    buffer_load_dwordx4 a[120:123], v2, s[44:47], s5 offen sc1
    v_cvt_pk_bf16_f32 v8, v100, v101
    v_cvt_pk_bf16_f32 v9, v102, v103
    ds_write_b128 v26, v[6:9] offset:1024
    s_waitcnt lgkmcnt(0)
    s_barrier
    ds_read_b128 v[20:23], v35
    ds_read_b128 v[38:41], v35 offset:1024
    ds_read_b128 v[92:95], v35 offset:2048
    ds_read_b128 v[96:99], v35 offset:3072
    ds_read_b128 v[108:111], v35 offset:4096
    ds_read_b128 v[112:115], v35 offset:5120
    ds_read_b128 v[116:119], v35 offset:6144
    ds_read_b128 v[120:123], v35 offset:7168
    s_mul_i32 s2, s53, 28672
    buffer_load_dwordx4 a[124:127], v3, s[44:47], s5 offen sc1
    s_add_u32 s2, s2, 49152
    v_add_u32 v14, s2, v1
    v_lshlrev_b32 v15, 12, v24
    v_lshl_add_u32 v15, v37, 4, v15
    s_mul_i32 s19, s52, 458752
    s_lshl_b32 s3, s59, 7
    s_add_u32 s19, s19, s3
    s_add_u32 s19, s19, 3145728
    s_mov_b32 s73, s19
    buffer_load_dwordx4 a[128:131], v2, s[44:47], s6 offen sc1
    s_add_u32 s2, s21, 106496
    v_add_u32 v16, s2, v1
    s_lshl_b32 s2, s59, 1
    s_add_u32 s2, s2, s54
    s_mul_i32 s2, s2, 28672
    s_waitcnt lgkmcnt(7)
    v_mfma_f32_16x16x32_bf16 v[6:9], v[20:23], v[68:71], 0
    s_lshl_b32 s3, s60, 7
    s_add_u32 s2, s2, s3
    s_waitcnt lgkmcnt(6)
    v_mfma_f32_16x16x32_bf16 v[44:47], v[38:41], v[68:71], 0
    s_lshl_b32 s3, s53, 6
    s_add_u32 s2, s2, s3
    s_waitcnt lgkmcnt(5)
    v_mfma_f32_16x16x32_bf16 v[6:9], v[92:95], v[74:77], v[6:9]
    buffer_load_dwordx4 a[132:135], v3, s[44:47], s6 offen sc1
    s_waitcnt lgkmcnt(4)
    v_mfma_f32_16x16x32_bf16 v[44:47], v[96:99], v[74:77], v[44:47]
    v_mul_u32_u24 v17, 896, v29
    v_lshl_add_u32 v17, v27, 4, v17
    s_waitcnt lgkmcnt(3)
    v_mfma_f32_16x16x32_bf16 v[6:9], v[108:111], v[86:89], v[6:9]
    v_add_u32 v17, s2, v17
    s_xor_b32 s2, s52, 1
    s_waitcnt lgkmcnt(2)
    v_mfma_f32_16x16x32_bf16 v[44:47], v[112:115], v[86:89], v[44:47]
    s_add_u32 s89, s22, 131072
    s_mul_i32 s2, s2, 12288
    s_waitcnt lgkmcnt(1)
    v_mfma_f32_16x16x32_bf16 v[6:9], v[116:119], v[80:83], v[6:9]
    buffer_load_dword v13, v42, s[44:47], s89 offen sc1
    s_waitcnt lgkmcnt(0)
    v_mfma_f32_16x16x32_bf16 v[44:47], v[120:123], v[80:83], v[44:47]
    buffer_load_dwordx4 a[136:139], v2, s[44:47], s7 offen sc1
    v_mfma_f32_16x16x32_bf16 v[48:51], v[20:23], v[70:73], 0
    v_add_u32 v10, s2, v1
    s_xor_b32 s2, s52, 2
    v_mfma_f32_16x16x32_bf16 v[52:55], v[38:41], v[70:73], 0
    s_mul_i32 s2, s2, 12288
    v_add_u32 v11, s2, v1
    v_mfma_f32_16x16x32_bf16 v[48:51], v[92:95], v[76:79], v[48:51]
    s_xor_b32 s2, s52, 3
    s_mul_i32 s2, s2, 12288
    v_mfma_f32_16x16x32_bf16 v[52:55], v[96:99], v[76:79], v[52:55]
    buffer_load_dwordx4 a[140:143], v3, s[44:47], s7 offen sc1
    v_mfma_f32_16x16x32_bf16 v[48:51], v[108:111], v[88:91], v[48:51]
    v_add_u32_e64 v12, s2, v1
    s_mul_i32 s2, s52, 12288
    v_mfma_f32_16x16x32_bf16 v[52:55], v[112:115], v[88:91], v[52:55]
    v_add_u32 v18, s2, v1
    v_lshlrev_b32 v24, 10, v27
    v_mfma_f32_16x16x32_bf16 v[48:51], v[116:119], v[82:85], v[48:51]
    v_lshl_add_u32 v24, v30, 7, v24
    v_lshl_add_u32 v24, v31, 4, v24
    v_mfma_f32_16x16x32_bf16 v[52:55], v[120:123], v[82:85], v[52:55]
    buffer_load_dwordx4 a[144:147], v2, s[44:47], s8 offen sc1
    v_cvt_pk_bf16_f32 v56, v6, v7
    v_cvt_pk_bf16_f32 v57, v8, v9
    v_cvt_pk_bf16_f32 v58, v44, v45
    v_cvt_pk_bf16_f32 v59, v46, v47
    buffer_store_dwordx4 v[56:59], v36, s[44:47], s17 offen sc1
    v_cvt_pk_bf16_f32 v20, v48, v49
    v_cvt_pk_bf16_f32 v21, v50, v51
    v_cvt_pk_bf16_f32 v22, v52, v53
    v_cvt_pk_bf16_f32 v23, v54, v55
    buffer_store_dwordx4 v[20:23], v36, s[44:47], s23 offen sc1
    v_lshl_add_u32 v24, v28, 3, v24
    buffer_load_dwordx4 a[148:151], v3, s[44:47], s8 offen sc1
    v_lshrrev_b32 v25, 1, v30
    v_xor_b32 v25, s54, v25
    v_lshl_add_u32 v24, v25, 6, v24
    v_add_u32 v19, 106496, v24
    s_mul_i32 s13, s59, 7
    s_add_u32 s13, s13, s60
    s_lshl_b32 s13, s13, 14
    s_add_u32 s13, s13, s69
    s_add_u32 s13, s13, 17825792
    s_xor_b32 s12, s59, 1
    s_mul_i32 s12, s12, 7
    buffer_load_dwordx4 a[152:155], v2, s[44:47], s9 offen sc1
    s_add_u32 s12, s12, s60
    s_lshl_b32 s12, s12, 14
    s_add_u32 s12, s12, s69
    s_add_u32 s12, s12, 17825792
    v_bfe_u32 v6, v34, 0, 8
    v_bfe_u32 v7, v34, 8, 8
    v_bfe_u32 v8, v34, 16, 8
    v_bfe_u32 v9, v34, 24, 8
    s_mov_b32 s63, 0xffffff00
    buffer_load_dwordx4 a[156:159], v3, s[44:47], s9 offen sc1
    s_waitcnt vmcnt(13)
    v_mfma_f32_32x32x16_bf16 v[44:59], a[0:3], a[116:119], 0
    v_mfma_f32_32x32x16_bf16 v[60:75], a[4:7], a[112:115], 0
    v_mfma_f32_32x32x16_bf16 v[76:91], a[4:7], a[116:119], 0
    buffer_load_dwordx4 a[160:163], v2, s[44:47], s10 offen sc1
    v_mfma_f32_32x32x16_bf16 v[92:107], a[0:3], a[112:115], 0
    buffer_load_dwordx4 a[164:167], v3, s[44:47], s10 offen sc1
    s_waitcnt vmcnt(13)
    v_mfma_f32_32x32x16_bf16 v[44:59], a[8:11], a[124:127], v[44:59]
    s_barrier
    v_mfma_f32_32x32x16_bf16 v[60:75], a[12:15], a[120:123], v[60:75]
    v_mfma_f32_32x32x16_bf16 v[76:91], a[12:15], a[124:127], v[76:91]
    buffer_load_dwordx4 a[168:171], v4, s[44:47], s4 offen sc1
    v_mfma_f32_32x32x16_bf16 v[92:107], a[8:11], a[120:123], v[92:107]
    s_lshl_b32 s2, s60, 1
    s_add_u32 s2, s2, s53
    s_lshl_b32 s2, s2, 5
    v_add_u32 v24, s2, v29
    v_cvt_f32_u32_e64 v24, v24
    v_mul_f32 v24, 0x3b124925, v24
    buffer_load_dwordx4 a[172:175], v5, s[44:47], s4 offen sc1
    s_waitcnt vmcnt(13)
    v_mfma_f32_32x32x16_bf16 v[44:59], a[16:19], a[132:135], v[44:59]
    s_mul_i32 s2, s54, 112
    s_add_u32 s2, s2, 1
    v_lshl_add_u32 v25, v27, 2, s2
    v_cvt_f32_u32_e64 v25, v25
    v_mul_f32 v26, 0x41000000, v24
    v_mul_f32_e64 v25, v25, v24
    v_mfma_f32_32x32x16_bf16 v[60:75], a[20:23], a[128:131], v[60:75]
    buffer_load_dwordx4 a[176:179], v4, s[44:47], s5 offen sc1
    v_cos_f32_e64 v26, v26
    s_add_u32 s2, s21, 49152
    v_add_u32_e64 v32, s2, v1
    v_mfma_f32_32x32x16_bf16 v[76:91], a[20:23], a[132:135], v[76:91]
    v_add_f32 v26, v26, v26
    v_mov_b32 v172, v25
    v_sin_f32 v173, v172
    v_cos_f32 v172, v172
    v_mfma_f32_32x32x16_bf16 v[92:107], a[16:19], a[128:131], v[92:107]
    buffer_load_dwordx4 a[180:183], v5, s[44:47], s5 offen sc1
    v_fmamk_f32 v174, v24, 0x3f800000, v25
    v_sin_f32 v175, v174
    s_waitcnt vmcnt(12)
    v_mfma_f32_32x32x16_bf16 v[44:59], a[24:27], a[140:143], v[44:59]
    v_cos_f32_e64 v174, v174
    v_fmamk_f32 v176, v24, 0x40000000, v25
    v_sin_f32_e64 v177, v176
    v_mfma_f32_32x32x16_bf16 v[60:75], a[28:31], a[136:139], v[60:75]
    buffer_load_dwordx4 a[184:187], v4, s[44:47], s6 offen sc1
    v_cos_f32_e64 v176, v176
    v_fmamk_f32 v178, v24, 0x40400000, v25
    v_mfma_f32_32x32x16_bf16 v[76:91], a[28:31], a[140:143], v[76:91]
    v_sin_f32 v179, v178
    v_cos_f32 v178, v178
    v_cvt_pk_bf16_f32 v20, v172, -v173
    v_cvt_pk_bf16_f32 v21, v174, -v175
    v_mfma_f32_32x32x16_bf16 v[92:107], a[24:27], a[136:139], v[92:107]
    buffer_load_dwordx4 a[188:191], v5, s[44:47], s6 offen sc1
    v_cvt_pk_bf16_f32 v22, v176, -v177
    v_cvt_pk_bf16_f32 v23, v178, -v179
    s_waitcnt vmcnt(10)
    v_mfma_f32_32x32x16_bf16 v[44:59], a[32:35], a[148:151], v[44:59]
    ds_write_b128 v32, v[20:23]
    v_fmamk_f32 v180, v24, 0x41000000, v25
    v_mfma_f32_32x32x16_bf16 v[60:75], a[36:39], a[144:147], v[60:75]
    buffer_load_dwordx4 a[192:195], v4, s[44:47], s7 offen sc1
    v_sin_f32 v181, v180
    v_cos_f32_e64 v180, v180
    v_mfma_f32_32x32x16_bf16 v[76:91], a[36:39], a[148:151], v[76:91]
    v_cmp_eq_u32 vcc, s62, v13
    s_nop 0
    s_cmp_eq_u64 vcc, exec
    s_cbranch_scc0 L_slow6
L_ok6:
    v_fmamk_f32 v182, v24, 0x41100000, v25
    v_mfma_f32_32x32x16_bf16 v[92:107], a[32:35], a[144:147], v[92:107]
    buffer_load_dwordx4 a[196:199], v5, s[44:47], s7 offen sc1
    v_sin_f32 v183, v182
    s_waitcnt vmcnt(10)
    v_mfma_f32_32x32x16_bf16 v[44:59], a[40:43], a[156:159], v[44:59]
    v_cos_f32_e64 v182, v182
    v_fmamk_f32 v184, v24, 0x41200000, v25
    v_sin_f32_e64 v185, v184
    v_mfma_f32_32x32x16_bf16 v[60:75], a[44:47], a[152:155], v[60:75]
    buffer_load_dwordx4 a[200:203], v4, s[44:47], s8 offen sc1
    v_cos_f32_e64 v184, v184
    v_fmamk_f32 v186, v24, 0x41300000, v25
    v_mfma_f32_32x32x16_bf16 v[76:91], a[44:47], a[156:159], v[76:91]
    v_sin_f32_e64 v187, v186
    v_cos_f32 v186, v186
    v_cvt_pk_bf16_f32 v20, v180, -v181
    v_cvt_pk_bf16_f32 v21, v182, -v183
    v_mfma_f32_32x32x16_bf16 v[92:107], a[40:43], a[152:155], v[92:107]
    buffer_load_dwordx4 a[204:207], v5, s[44:47], s8 offen sc1
    v_cvt_pk_bf16_f32 v22, v184, -v185
    v_cvt_pk_bf16_f32 v23, v186, -v187
    s_waitcnt vmcnt(10)
    v_mfma_f32_32x32x16_bf16 v[44:59], a[48:51], a[164:167], v[44:59]
    ds_write_b128 v32, v[20:23] offset:1024
    v_fma_f32 v172, v26, v180, -v172
    v_mfma_f32_32x32x16_bf16 v[60:75], a[52:55], a[160:163], v[60:75]
    v_add_u32 v2, 4096, v2
    v_add_u32 v3, 4096, v3
    buffer_load_dwordx4 a[208:211], v2, s[44:47], s4 offen sc1
    v_fma_f32 v173, v26, v181, -v173
    v_fma_f32 v174, v26, v182, -v174
    v_mfma_f32_32x32x16_bf16 v[76:91], a[52:55], a[164:167], v[76:91]
    v_fma_f32 v175, v26, v183, -v175
    v_fma_f32 v176, v26, v184, -v176
    v_fma_f32 v177, v26, v185, -v177
    v_fma_f32 v178, v26, v186, -v178
    v_fma_f32 v179, v26, v187, -v179
    v_cvt_pk_bf16_f32 v28, v172, -v173
    v_mfma_f32_32x32x16_bf16 v[92:107], a[48:51], a[160:163], v[92:107]
    buffer_load_dwordx4 a[212:215], v3, s[44:47], s4 offen sc1
    v_cvt_pk_bf16_f32 v29, v174, -v175
    v_cvt_pk_bf16_f32 v30, v176, -v177
    v_cvt_pk_bf16_f32 v31, v178, -v179
    s_waitcnt vmcnt(10)
    v_mfma_f32_32x32x16_bf16 v[108:123], a[0:3], a[172:175], 0
    ds_write_b128 v32, v[28:31] offset:2048
    v_fma_f32 v180, v26, v172, -v180
    v_mfma_f32_32x32x16_bf16 v[124:139], a[4:7], a[168:171], 0
    buffer_load_dwordx4 a[216:219], v2, s[44:47], s5 offen sc1
    v_fma_f32 v181, v26, v173, -v181
    v_fma_f32 v182, v26, v174, -v182
    v_fma_f32 v183, v26, v175, -v183
    v_fma_f32 v184, v26, v176, -v184
    v_mfma_f32_32x32x16_bf16 v[140:155], a[4:7], a[172:175], 0
    buffer_load_dwordx4 a[220:223], v3, s[44:47], s5 offen sc1
    v_fma_f32 v185, v26, v177, -v185
    v_fma_f32 v186, v26, v178, -v186
    v_fma_f32 v187, v26, v179, -v187
    v_cvt_pk_bf16_f32 v20, v180, -v181
    v_mfma_f32_32x32x16_bf16 v[156:171], a[0:3], a[168:171], 0
    v_cvt_pk_bf16_f32 v21, v182, -v183
    v_cvt_pk_bf16_f32 v22, v184, -v185
    v_cvt_pk_bf16_f32 v23, v186, -v187
    s_waitcnt vmcnt(10)
    v_mfma_f32_32x32x16_bf16 v[108:123], a[8:11], a[180:183], v[108:123]
    buffer_load_dwordx4 a[112:115], v2, s[44:47], s6 offen sc1
    ds_write_b128 v32, v[20:23] offset:3072
    v_mfma_f32_32x32x16_bf16 v[124:139], a[12:15], a[176:179], v[124:139]
    v_fma_f32 v172, v26, v180, -v172
    v_fma_f32 v173, v26, v181, -v173
    v_fma_f32 v174, v26, v182, -v174
    v_fma_f32 v175, v26, v183, -v175
    v_fma_f32 v176, v26, v184, -v176
    v_fma_f32 v177, v26, v185, -v177
    v_mfma_f32_32x32x16_bf16 v[140:155], a[12:15], a[180:183], v[140:155]
    buffer_load_dwordx4 a[116:119], v3, s[44:47], s6 offen sc1
    v_fma_f32 v178, v26, v186, -v178
    v_fma_f32 v179, v26, v187, -v179
    v_cvt_pk_bf16_f32 v28, v172, -v173
    v_cvt_pk_bf16_f32 v29, v174, -v175
    v_mfma_f32_32x32x16_bf16 v[156:171], a[8:11], a[176:179], v[156:171]
    v_cvt_pk_bf16_f32 v30, v176, -v177
    v_cvt_pk_bf16_f32 v31, v178, -v179
    s_waitcnt vmcnt(10)
    v_mfma_f32_32x32x16_bf16 v[108:123], a[16:19], a[188:191], v[108:123]
    buffer_load_dwordx4 a[0:3], v2, s[44:47], s7 offen sc1
    ds_write_b128 v32, v[28:31] offset:4096
    v_mfma_f32_32x32x16_bf16 v[124:139], a[20:23], a[184:187], v[124:139]
    v_fma_f32 v180, v26, v172, -v180
    v_fma_f32 v181, v26, v173, -v181
    v_fma_f32 v182, v26, v174, -v182
    v_fma_f32 v183, v26, v175, -v183
    v_fma_f32 v184, v26, v176, -v184
    v_fma_f32 v185, v26, v177, -v185
    v_mfma_f32_32x32x16_bf16 v[140:155], a[20:23], a[188:191], v[140:155]
    buffer_load_dwordx4 a[4:7], v3, s[44:47], s7 offen sc1
    v_fma_f32 v186, v26, v178, -v186
    v_fma_f32 v187, v26, v179, -v187
    v_cvt_pk_bf16_f32 v20, v180, -v181
    v_cvt_pk_bf16_f32 v21, v182, -v183
    v_mfma_f32_32x32x16_bf16 v[156:171], a[16:19], a[184:187], v[156:171]
    v_cvt_pk_bf16_f32 v22, v184, -v185
    v_cvt_pk_bf16_f32 v23, v186, -v187
    s_waitcnt vmcnt(10)
    v_mfma_f32_32x32x16_bf16 v[108:123], a[24:27], a[196:199], v[108:123]
    buffer_load_dwordx4 a[8:11], v2, s[44:47], s8 offen sc1
    ds_write_b128 v32, v[20:23] offset:5120
    v_mfma_f32_32x32x16_bf16 v[124:139], a[28:31], a[192:195], v[124:139]
    v_fma_f32 v172, v26, v180, -v172
    v_fma_f32 v173, v26, v181, -v173
    v_fma_f32 v174, v26, v182, -v174
    v_fma_f32 v175, v26, v183, -v175
    v_fma_f32 v176, v26, v184, -v176
    v_fma_f32 v177, v26, v185, -v177
    v_mfma_f32_32x32x16_bf16 v[140:155], a[28:31], a[196:199], v[140:155]
    buffer_load_dwordx4 a[12:15], v3, s[44:47], s8 offen sc1
    v_fma_f32 v178, v26, v186, -v178
    v_fma_f32 v179, v26, v187, -v179
    v_cvt_pk_bf16_f32 v28, v172, -v173
    v_cvt_pk_bf16_f32 v29, v174, -v175
    v_mfma_f32_32x32x16_bf16 v[156:171], a[24:27], a[192:195], v[156:171]
    v_cvt_pk_bf16_f32 v30, v176, -v177
    v_cvt_pk_bf16_f32 v31, v178, -v179
    s_waitcnt vmcnt(10)
    v_mfma_f32_32x32x16_bf16 v[108:123], a[32:35], a[204:207], v[108:123]
    buffer_load_dwordx4 a[16:19], v2, s[44:47], s9 offen sc1
    ds_write_b128 v32, v[28:31] offset:6144
    v_mfma_f32_32x32x16_bf16 v[124:139], a[36:39], a[200:203], v[124:139]
    buffer_load_dwordx4 a[20:23], v3, s[44:47], s9 offen sc1
    v_fma_f32 v180, v26, v172, -v180
    v_fma_f32 v181, v26, v173, -v181
    v_fma_f32 v182, v26, v174, -v182
    v_fma_f32 v183, v26, v175, -v183
    v_mfma_f32_32x32x16_bf16 v[140:155], a[36:39], a[204:207], v[140:155]
    v_fma_f32 v184, v26, v176, -v184
    v_fma_f32 v185, v26, v177, -v185
    v_fma_f32 v186, v26, v178, -v186
    v_fma_f32 v187, v26, v179, -v187
    v_cvt_pk_bf16_f32 v20, v180, -v181
    v_cvt_pk_bf16_f32 v21, v182, -v183
    v_mfma_f32_32x32x16_bf16 v[156:171], a[32:35], a[200:203], v[156:171]
    buffer_load_dwordx4 a[140:143], v2, s[44:47], s10 offen sc1
    v_cvt_pk_bf16_f32 v22, v184, -v185
    v_cvt_pk_bf16_f32 v23, v186, -v187
    s_waitcnt vmcnt(11)
    v_mfma_f32_32x32x16_bf16 v[44:59], a[56:59], a[212:215], v[44:59]
    ds_write_b128 v32, v[20:23] offset:7168
    v_fma_f32 v172, v26, v180, -v172
    v_mfma_f32_32x32x16_bf16 v[60:75], a[60:63], a[208:211], v[60:75]
    buffer_load_dwordx4 a[144:147], v3, s[44:47], s10 offen sc1
    v_fma_f32 v173, v26, v181, -v173
    v_fma_f32 v174, v26, v182, -v174
    v_fma_f32 v175, v26, v183, -v175
    v_fma_f32 v176, v26, v184, -v176
    v_mfma_f32_32x32x16_bf16 v[76:91], a[60:63], a[212:215], v[76:91]
    v_fma_f32 v177, v26, v185, -v177
    v_fma_f32 v178, v26, v186, -v178
    v_fma_f32 v179, v26, v187, -v179
    v_cvt_pk_bf16_f32 v28, v172, -v173
    v_cvt_pk_bf16_f32 v29, v174, -v175
    v_cvt_pk_bf16_f32 v30, v176, -v177
    v_mfma_f32_32x32x16_bf16 v[92:107], a[56:59], a[208:211], v[92:107]
    buffer_load_dwordx4 a[24:27], v4, s[44:47], s9 offen sc1
    v_cvt_pk_bf16_f32 v31, v178, -v179
    s_waitcnt vmcnt(11)
    v_mfma_f32_32x32x16_bf16 v[44:59], a[64:67], a[220:223], v[44:59]
    s_add_u32 m0, s21, 106496
    ds_write_b128 v32, v[28:31] offset:8192
    v_mfma_f32_32x32x16_bf16 v[60:75], a[68:71], a[216:219], v[60:75]
    buffer_load_dwordx4 v15, s[44:47], s19 offen sc1 lds
    v_fma_f32 v180, v26, v172, -v180
    v_fma_f32 v181, v26, v173, -v181
    v_fma_f32 v182, v26, v174, -v182
    v_fma_f32 v183, v26, v175, -v183
    v_mfma_f32_32x32x16_bf16 v[76:91], a[68:71], a[220:223], v[76:91]
    v_fma_f32 v184, v26, v176, -v184
    v_fma_f32 v185, v26, v177, -v185
    v_fma_f32 v186, v26, v178, -v186
    v_fma_f32 v187, v26, v179, -v187
    v_cvt_pk_bf16_f32 v20, v180, -v181
    v_cvt_pk_bf16_f32 v21, v182, -v183
    v_mfma_f32_32x32x16_bf16 v[92:107], a[64:67], a[216:219], v[92:107]
    buffer_load_dwordx4 a[28:31], v5, s[44:47], s9 offen sc1
    v_cvt_pk_bf16_f32 v22, v184, -v185
    v_cvt_pk_bf16_f32 v23, v186, -v187
    s_waitcnt vmcnt(11)
    v_mfma_f32_32x32x16_bf16 v[44:59], a[72:75], a[116:119], v[44:59]
    ds_write_b128 v32, v[20:23] offset:9216
    v_fma_f32 v172, v26, v180, -v172
    v_mfma_f32_32x32x16_bf16 v[60:75], a[76:79], a[112:115], v[60:75]
    buffer_load_dwordx4 a[32:35], v4, s[44:47], s10 offen sc1
    v_fma_f32 v173, v26, v181, -v173
    v_fma_f32 v174, v26, v182, -v174
    v_fma_f32 v175, v26, v183, -v175
    v_fma_f32 v176, v26, v184, -v176
    v_mfma_f32_32x32x16_bf16 v[76:91], a[76:79], a[116:119], v[76:91]
    v_fma_f32 v177, v26, v185, -v177
    v_fma_f32 v178, v26, v186, -v178
    v_fma_f32 v179, v26, v187, -v179
    v_cvt_pk_bf16_f32 v28, v172, -v173
    v_cvt_pk_bf16_f32 v29, v174, -v175
    v_cvt_pk_bf16_f32 v30, v176, -v177
    v_mfma_f32_32x32x16_bf16 v[92:107], a[72:75], a[112:115], v[92:107]
    s_add_u32 s19, s19, 31744
    buffer_load_dwordx4 v15, s[44:47], s19 offen offset:1024 sc1 lds
    v_cvt_pk_bf16_f32 v31, v178, -v179
    ds_write_b128 v32, v[28:31] offset:10240
    v_fma_f32 v180, v26, v172, -v180
    v_fma_f32 v181, v26, v173, -v181
    v_fma_f32 v182, v26, v174, -v182
    buffer_load_dwordx4 a[36:39], v5, s[44:47], s10 offen sc1
    s_waitcnt vmcnt(12)
    v_mfma_f32_32x32x16_bf16 v[44:59], a[80:83], a[4:7], v[44:59]
    v_fma_f32 v183, v26, v175, -v183
    v_fma_f32 v184, v26, v176, -v184
    v_fma_f32 v185, v26, v177, -v185
    v_fma_f32 v186, v26, v178, -v186
    v_fma_f32 v187, v26, v179, -v187
    v_cvt_pk_bf16_f32 v20, v180, -v181
    v_mfma_f32_32x32x16_bf16 v[60:75], a[84:87], a[0:3], v[60:75]
    v_cvt_pk_bf16_f32 v21, v182, -v183
    v_cvt_pk_bf16_f32 v22, v184, -v185
    v_cvt_pk_bf16_f32 v23, v186, -v187
    v_mfma_f32_32x32x16_bf16 v[76:91], a[84:87], a[4:7], v[76:91]
    v_add_u32 v4, 4096, v4
    v_add_u32 v5, 4096, v5
    buffer_load_dwordx4 a[176:179], v4, s[44:47], s4 offen sc1
    v_mfma_f32_32x32x16_bf16 v[92:107], a[80:83], a[0:3], v[92:107]
    ds_write_b128 v32, v[20:23] offset:11264
    v_fma_f32 v172, v26, v180, -v172
    s_add_u32 s19, s19, 31744
    buffer_load_dwordx4 v15, s[44:47], s19 offen offset:2048 sc1 lds
    v_fma_f32 v173, v26, v181, -v173
    v_fma_f32 v174, v26, v182, -v174
    v_fma_f32 v175, v26, v183, -v175
    v_fma_f32 v176, v26, v184, -v176
    v_fma_f32 v177, v26, v185, -v177
    v_fma_f32 v178, v26, v186, -v178
    v_fma_f32 v179, v26, v187, -v179
    v_cvt_pk_bf16_f32 v28, v172, -v173
    v_cvt_pk_bf16_f32 v29, v174, -v175
    buffer_load_dwordx4 a[180:183], v5, s[44:47], s4 offen sc1
    s_waitcnt vmcnt(13)
    v_mfma_f32_32x32x16_bf16 v[44:59], a[88:91], a[12:15], v[44:59]
    v_cvt_pk_bf16_f32 v30, v176, -v177
    v_cvt_pk_bf16_f32 v31, v178, -v179
    v_mfma_f32_32x32x16_bf16 v[60:75], a[92:95], a[8:11], v[60:75]
    ds_write_b128 v32, v[28:31] offset:12288
    v_fma_f32 v180, v26, v172, -v180
    v_mfma_f32_32x32x16_bf16 v[76:91], a[92:95], a[12:15], v[76:91]
    buffer_load_dwordx4 a[0:3], v4, s[44:47], s5 offen sc1
    v_fma_f32 v181, v26, v173, -v181
    v_fma_f32 v182, v26, v174, -v182
    v_fma_f32 v183, v26, v175, -v183
    v_fma_f32 v184, v26, v176, -v184
    v_mfma_f32_32x32x16_bf16 v[92:107], a[88:91], a[8:11], v[92:107]
    v_fma_f32 v185, v26, v177, -v185
    v_fma_f32 v186, v26, v178, -v186
    v_fma_f32 v187, v26, v179, -v187
    v_and_b32 v13, s54, v27
    v_cvt_f32_u32 v13, v13
    v_fma_f32 v13, -0.5, v13, 1.0
    s_add_u32 s19, s19, 31744
    buffer_load_dwordx4 v15, s[44:47], s19 offen offset:3072 sc1 lds
    v_mul_f32 v186, v13, v186
    v_cvt_pk_bf16_f32 v20, v180, -v181
    v_cvt_pk_bf16_f32 v21, v182, -v183
    v_cvt_pk_bf16_f32 v22, v184, -v185
    v_cvt_pk_bf16_f32 v23, v186, -v187
    ds_write_b128 v32, v[20:23] offset:13312
    buffer_load_dwordx4 a[4:7], v5, s[44:47], s5 offen sc1
    s_waitcnt vmcnt(14)
    v_mfma_f32_32x32x16_bf16 v[44:59], a[96:99], a[20:23], v[44:59]
    s_waitcnt lgkmcnt(0)
    s_barrier
    v_mfma_f32_32x32x16_bf16 v[60:75], a[100:103], a[16:19], v[60:75]
    v_mfma_f32_32x32x16_bf16 v[76:91], a[100:103], a[20:23], v[76:91]
    buffer_load_dwordx4 a[196:199], v4, s[44:47], s6 offen sc1
    v_mfma_f32_32x32x16_bf16 v[92:107], a[96:99], a[16:19], v[92:107]
    s_add_u32 m0, s21, 110592
    s_add_u32 s19, s19, 35840
    buffer_load_dwordx4 v15, s[44:47], s19 offen sc1 lds
    buffer_load_dwordx4 a[200:203], v5, s[44:47], s6 offen sc1
    s_waitcnt vmcnt(15)
    v_mfma_f32_32x32x16_bf16 v[44:59], a[104:107], a[144:147], v[44:59]
    ds_read_b128 a[112:115], v14
    v_mfma_f32_32x32x16_bf16 v[60:75], a[108:111], a[140:143], v[60:75]
    ds_read_b128 a[116:119], v14 offset:1024
    v_mfma_f32_32x32x16_bf16 v[76:91], a[108:111], a[144:147], v[76:91]
    ds_read_b128 a[120:123], v14 offset:2048
    buffer_load_dwordx4 a[8:11], v4, s[44:47], s7 offen sc1
    v_mfma_f32_32x32x16_bf16 v[92:107], a[104:107], a[140:143], v[92:107]
    s_add_u32 s19, s19, 31744
    buffer_load_dwordx4 v15, s[44:47], s19 offen offset:1024 sc1 lds
    buffer_load_dwordx4 a[12:15], v5, s[44:47], s7 offen sc1
    s_waitcnt vmcnt(15)
    v_mfma_f32_32x32x16_bf16 v[108:123], a[40:43], a[28:31], v[108:123]
    ds_read_b128 a[124:127], v14 offset:3072
    ds_write_b128 v10, v[44:47]
    v_mfma_f32_32x32x16_bf16 v[124:139], a[44:47], a[24:27], v[124:139]
    ds_read_b128 a[128:131], v14 offset:4096
    buffer_load_dwordx4 a[16:19], v4, s[44:47], s8 offen sc1
    ds_write_b128 v10, v[48:51] offset:1024
    v_mfma_f32_32x32x16_bf16 v[140:155], a[44:47], a[28:31], v[140:155]
    ds_read_b128 a[132:135], v14 offset:5120
    ds_write_b128 v10, v[52:55] offset:2048
    v_mfma_f32_32x32x16_bf16 v[156:171], a[40:43], a[24:27], v[156:171]
    s_add_u32 s19, s19, 31744
    buffer_load_dwordx4 v15, s[44:47], s19 offen offset:2048 sc1 lds
    buffer_load_dwordx4 a[20:23], v5, s[44:47], s8 offen sc1
    s_waitcnt vmcnt(15)
    v_mfma_f32_32x32x16_bf16 v[108:123], a[48:51], a[36:39], v[108:123]
    ds_read_b128 a[136:139], v14 offset:6144
    ds_write_b128 v10, v[56:59] offset:3072
    v_mfma_f32_32x32x16_bf16 v[124:139], a[52:55], a[32:35], v[124:139]
    ds_read_b128 a[140:143], v14 offset:7168
    buffer_load_dwordx4 a[224:227], v4, s[44:47], s9 offen sc1
    ds_write_b128 v11, v[60:63] offset:4096
    v_mfma_f32_32x32x16_bf16 v[140:155], a[52:55], a[36:39], v[140:155]
    ds_read_b128 a[144:147], v14 offset:8192
    ds_write_b128 v11, v[64:67] offset:5120
    v_mfma_f32_32x32x16_bf16 v[156:171], a[48:51], a[32:35], v[156:171]
    s_add_u32 s19, s19, 31744
    buffer_load_dwordx4 v15, s[44:47], s19 offen offset:3072 sc1 lds
    buffer_load_dwordx4 a[228:231], v5, s[44:47], s9 offen sc1
    s_waitcnt vmcnt(15)
    v_mfma_f32_32x32x16_bf16 v[108:123], a[56:59], a[180:183], v[108:123]
    ds_read_b128 a[148:151], v14 offset:9216
    ds_write_b128 v11, v[68:71] offset:6144
    v_mfma_f32_32x32x16_bf16 v[124:139], a[60:63], a[176:179], v[124:139]
    ds_read_b128 a[152:155], v14 offset:10240
    buffer_load_dwordx4 a[24:27], v4, s[44:47], s10 offen sc1
    ds_write_b128 v11, v[72:75] offset:7168
    v_mfma_f32_32x32x16_bf16 v[140:155], a[60:63], a[180:183], v[140:155]
    ds_read_b128 a[156:159], v14 offset:11264
    s_add_u32 m0, s21, 114688
    ds_write_b128 v12, v[76:79] offset:8192
    v_mfma_f32_32x32x16_bf16 v[156:171], a[56:59], a[176:179], v[156:171]
    s_add_u32 s19, s19, 35840
    buffer_load_dwordx4 v15, s[44:47], s19 offen sc1 lds
    buffer_load_dwordx4 a[28:31], v5, s[44:47], s10 offen sc1
    s_waitcnt vmcnt(15)
    v_mfma_f32_32x32x16_bf16 v[108:123], a[64:67], a[4:7], v[108:123]
    ds_read_b128 a[160:163], v14 offset:12288
    ds_write_b128 v12, v[80:83] offset:9216
    v_mfma_f32_32x32x16_bf16 v[124:139], a[68:71], a[0:3], v[124:139]
    ds_read_b128 a[164:167], v14 offset:13312
    s_add_u32 s19, s19, 31744
    buffer_load_dwordx4 v15, s[44:47], s19 offen offset:1024 sc1 lds
    v_mfma_f32_32x32x16_bf16 v[140:155], a[68:71], a[4:7], v[140:155]
    ds_read_b128 a[168:171], v14 offset:14336
    ds_write_b128 v12, v[84:87] offset:10240
    v_mfma_f32_32x32x16_bf16 v[156:171], a[64:67], a[0:3], v[156:171]
    s_add_u32 s19, s19, 31744
    buffer_load_dwordx4 v15, s[44:47], s19 offen offset:2048 sc1 lds
    s_waitcnt vmcnt(14)
    v_mfma_f32_32x32x16_bf16 v[108:123], a[72:75], a[200:203], v[108:123]
    ds_read_b128 a[172:175], v14 offset:15360
    ds_write_b128 v12, v[88:91] offset:11264
    v_mfma_f32_32x32x16_bf16 v[124:139], a[76:79], a[196:199], v[124:139]
    ds_read_b128 a[176:179], v14 offset:16384
    s_add_u32 s19, s19, 31744
    buffer_load_dwordx4 v15, s[44:47], s19 offen offset:3072 sc1 lds
    s_waitcnt lgkmcnt(1)
    s_barrier
    v_mfma_f32_32x32x16_bf16 v[140:155], a[76:79], a[200:203], v[140:155]
    ds_read_b128 a[180:183], v14 offset:17408
    s_add_u32 m0, s21, 118784
    ds_read_b128 v[2:5], v18
    ds_read_b128 v[20:23], v18 offset:4096
    ds_read_b128 v[24:27], v18 offset:8192
    ds_read_b128 v[28:31], v18 offset:1024
    v_mfma_f32_32x32x16_bf16 v[156:171], a[72:75], a[196:199], v[156:171]
    s_add_u32 s19, s19, 35840
    buffer_load_dwordx4 v15, s[44:47], s19 offen sc1 lds
    ds_read_b128 v[36:39], v18 offset:5120
    ds_read_b128 v[40:43], v18 offset:9216
    s_waitcnt vmcnt(13)
    v_mfma_f32_32x32x16_bf16 v[108:123], a[80:83], a[12:15], v[108:123]
    ds_read_b128 a[184:187], v14 offset:18432
    s_add_u32 s19, s19, 31744
    buffer_load_dwordx4 v15, s[44:47], s19 offen offset:1024 sc1 lds
    ds_read_b128 v[44:47], v18 offset:2048
    ds_read_b128 v[48:51], v18 offset:6144
    v_mfma_f32_32x32x16_bf16 v[124:139], a[84:87], a[8:11], v[124:139]
    ds_read_b128 a[188:191], v14 offset:19456
    ds_read_b128 v[52:55], v18 offset:10240
    ds_read_b128 v[66:69], v18 offset:3072
    ds_read_b128 v[70:73], v18 offset:7168
    ds_read_b128 v[74:77], v18 offset:11264
    s_waitcnt lgkmcnt(13)
    v_add_f32_e64 v92, v92, v2
    v_mfma_f32_32x32x16_bf16 v[140:155], a[84:87], a[12:15], v[140:155]
    ds_read_b128 a[192:195], v14 offset:20480
    v_add_f32 v93, v93, v3
    v_add_f32 v94, v94, v4
    v_add_f32 v95, v95, v5
    s_waitcnt lgkmcnt(13)
    v_add_f32 v92, v92, v20
    v_add_f32 v93, v93, v21
    v_mfma_f32_32x32x16_bf16 v[156:171], a[80:83], a[8:11], v[156:171]
    v_add_f32 v94, v94, v22
    v_add_f32 v95, v95, v23
    s_waitcnt lgkmcnt(12)
    v_add_f32 v92, v92, v24
    v_add_f32_e64 v93, v93, v25
    v_add_f32 v94, v94, v26
    s_waitcnt vmcnt(11)
    v_mfma_f32_32x32x16_bf16 v[108:123], a[88:91], a[20:23], v[108:123]
    ds_read_b128 a[196:199], v14 offset:21504
    v_add_f32_e64 v95, v95, v27
    v_and_or_b32 v92, v92, s63, v6
    v_and_or_b32 v93, v93, s63, v7
    v_and_or_b32 v94, v94, s63, v8
    v_and_or_b32 v95, v95, s63, v9
    v_mfma_f32_32x32x16_bf16 v[124:139], a[92:95], a[16:19], v[124:139]
    ds_read_b128 a[200:203], v14 offset:22528
    buffer_store_dwordx4 v[92:95], v1, s[44:47], s12 offen sc1
    s_waitcnt lgkmcnt(13)
    v_add_f32 v96, v96, v28
    v_add_f32 v97, v97, v29
    v_add_f32 v98, v98, v30
    v_mfma_f32_32x32x16_bf16 v[140:155], a[92:95], a[20:23], v[140:155]
    ds_read_b128 a[204:207], v14 offset:23552
    v_add_f32 v99, v99, v31
    s_waitcnt lgkmcnt(13)
    v_add_f32 v96, v96, v36
    v_add_f32 v97, v97, v37
    v_add_f32 v98, v98, v38
    v_add_f32 v99, v99, v39
    v_mfma_f32_32x32x16_bf16 v[156:171], a[88:91], a[16:19], v[156:171]
    s_waitcnt lgkmcnt(12)
    v_add_f32 v96, v96, v40
    v_add_f32 v97, v97, v41
    v_add_f32 v98, v98, v42
    v_add_f32 v99, v99, v43
    v_and_or_b32 v96, v96, s63, v6
    s_waitcnt vmcnt(9)
    v_mfma_f32_32x32x16_bf16 v[108:123], a[96:99], a[228:231], v[108:123]
    ds_read_b128 a[208:211], v14 offset:24576
    v_and_or_b32 v97, v97, s63, v7
    v_and_or_b32 v98, v98, s63, v8
    v_and_or_b32 v99, v99, s63, v9
    s_waitcnt lgkmcnt(11)
    v_add_f32 v100, v100, v44
    v_add_f32_e64 v101, v101, v45
    v_mfma_f32_32x32x16_bf16 v[124:139], a[100:103], a[224:227], v[124:139]
    ds_read_b128 a[212:215], v14 offset:25600
    buffer_store_dwordx4 v[96:99], v1, s[44:47], s12 offen offset:1024 sc1
    v_add_f32 v102, v102, v46
    v_add_f32 v103, v103, v47
    s_waitcnt lgkmcnt(11)
    v_add_f32 v100, v100, v48
    v_mfma_f32_32x32x16_bf16 v[140:155], a[100:103], a[228:231], v[140:155]
    ds_read_b128 a[216:219], v14 offset:26624
    v_add_f32 v101, v101, v49
    v_add_f32 v102, v102, v50
    v_add_f32 v103, v103, v51
    s_waitcnt lgkmcnt(10)
    v_add_f32 v100, v100, v52
    v_add_f32 v101, v101, v53
    v_mfma_f32_32x32x16_bf16 v[156:171], a[96:99], a[224:227], v[156:171]
    v_add_f32 v102, v102, v54
    v_add_f32 v103, v103, v55
    v_and_or_b32 v100, v100, s63, v6
    v_and_or_b32 v101, v101, s63, v7
    v_and_or_b32 v102, v102, s63, v8
    s_waitcnt vmcnt(7)
    v_mfma_f32_32x32x16_bf16 v[108:123], a[104:107], a[28:31], v[108:123]
    ds_read_b128 a[220:223], v14 offset:27648
    v_and_or_b32 v103, v103, s63, v9
    s_waitcnt lgkmcnt(10)
    v_add_f32 v104, v104, v66
    v_add_f32 v105, v105, v67
    v_add_f32 v106, v106, v68
    v_add_f32 v107, v107, v69
    v_mfma_f32_32x32x16_bf16 v[124:139], a[108:111], a[24:27], v[124:139]
    buffer_store_dwordx4 v[100:103], v1, s[44:47], s12 offen offset:2048 sc1
    s_waitcnt lgkmcnt(9)
    v_add_f32 v104, v104, v70
    v_add_f32 v105, v105, v71
    v_add_f32 v106, v106, v72
    v_add_f32_e64 v107, v107, v73
    v_mfma_f32_32x32x16_bf16 v[140:155], a[108:111], a[28:31], v[140:155]
    s_waitcnt lgkmcnt(8)
    v_add_f32 v104, v104, v74
    v_add_f32 v105, v105, v75
    v_add_f32 v106, v106, v76
    v_add_f32 v107, v107, v77
    v_and_or_b32 v104, v104, s63, v6
    v_and_or_b32 v105, v105, s63, v7
    v_mfma_f32_32x32x16_bf16 v[156:171], a[104:107], a[24:27], v[156:171]
    v_and_or_b32 v106, v106, s63, v8
    v_and_or_b32 v107, v107, s63, v9
    buffer_store_dwordx4 v[104:107], v1, s[44:47], s12 offen offset:3072 sc1
    s_waitcnt vmcnt(4)
    ds_read_b32 v52, v16
    ds_read_b32 v53, v16 offset:1024
    ds_read_b32 v54, v16 offset:2048
    ds_read_b32 v55, v16 offset:3072
    ds_read_b32 v56, v16 offset:4096
    ds_read_b32 v57, v16 offset:5120
    ds_read_b32 v58, v16 offset:6144
    ds_read_b32 v59, v16 offset:7168
    ds_read_b32 v60, v16 offset:8192
    ds_read_b32 v61, v16 offset:9216
    ds_read_b32 v62, v16 offset:10240
    ds_read_b32 v63, v16 offset:11264
    ds_read_b32 v64, v16 offset:12288
    ds_read_b32 v65, v16 offset:13312
    s_waitcnt lgkmcnt(0)
    v_max3_u32 v52, v52, v53, v54
    v_max3_u32 v52, v52, v55, v56
    v_max3_u32 v52, v52, v57, v58
    v_max3_u32 v52, v52, v59, v60
    v_max3_u32 v52, v52, v61, v62
    v_max3_u32 v52, v52, v63, v64
    v_max_u32_e64 v52, v52, v65
    v_cmp_ne_u32 vcc, -1, v52
    s_nop 0
    s_cmp_eq_u64 vcc, exec
    s_cbranch_scc0 L_slow7
L_ok7:
    s_barrier
    ds_read_b64_tr_b16 a[0:1], v19
    ds_read_b64_tr_b16 a[2:3], v19 offset:512
    ds_read_b64_tr_b16 a[4:5], v19 offset:2048
    ds_read_b64_tr_b16 a[6:7], v19 offset:2560
    ds_read_b64_tr_b16 a[8:9], v19 offset:4096
    ds_read_b64_tr_b16 a[10:11], v19 offset:4608
    s_waitcnt lgkmcnt(4)
    v_mfma_f32_32x32x16_bf16 v[36:51], a[112:115], a[0:3], 0
    ds_read_b64_tr_b16 a[12:13], v19 offset:6144
    ds_read_b64_tr_b16 a[14:15], v19 offset:6656
    ds_write_b128 v10, v[108:111] offset:49152
    s_waitcnt lgkmcnt(5)
    v_mfma_f32_32x32x16_bf16 v[36:51], a[116:119], a[4:7], v[36:51]
    ds_read_b64_tr_b16 a[16:17], v19 offset:8192
    ds_read_b64_tr_b16 a[18:19], v19 offset:8704
    v_permlane32_swap_b32 v214, v216
    v_permlane32_swap_b32 v215, v217
    s_waitcnt lgkmcnt(5)
    v_mfma_f32_32x32x16_bf16 v[36:51], a[120:123], a[8:11], v[36:51]
    ds_read_b64_tr_b16 a[20:21], v19 offset:10240
    ds_read_b64_tr_b16 a[22:23], v19 offset:10752
    ds_write_b128 v10, v[112:115] offset:50176
    s_waitcnt lgkmcnt(6)
    v_mfma_f32_32x32x16_bf16 v[36:51], a[124:127], a[12:15], v[36:51]
    ds_read_b64_tr_b16 a[24:25], v19 offset:12288
    ds_read_b64_tr_b16 a[26:27], v19 offset:12800
    v_permlane32_swap_b32 v218, v220
    v_permlane32_swap_b32 v219, v221
    s_waitcnt lgkmcnt(5)
    v_mfma_f32_32x32x16_bf16 v[36:51], a[128:131], a[16:19], v[36:51]
    ds_read_b64_tr_b16 a[28:29], v19 offset:14336
    ds_read_b64_tr_b16 a[30:31], v19 offset:14848
    ds_write_b128 v10, v[116:119] offset:51200
    s_waitcnt lgkmcnt(6)
    v_mfma_f32_32x32x16_bf16 v[36:51], a[132:135], a[20:23], v[36:51]
    ds_read_b64_tr_b16 a[32:33], v19 offset:16384
    ds_read_b64_tr_b16 a[34:35], v19 offset:16896
    v_lshlrev_b32 v52, 16, v214
    v_and_b32 v53, 0xffff0000, v214
    s_waitcnt lgkmcnt(5)
    v_mfma_f32_32x32x16_bf16 v[36:51], a[136:139], a[24:27], v[36:51]
    ds_read_b64_tr_b16 a[0:1], v19 offset:18432
    ds_read_b64_tr_b16 a[2:3], v19 offset:18944
    ds_write_b128 v10, v[120:123] offset:52224
    s_waitcnt lgkmcnt(6)
    v_mfma_f32_32x32x16_bf16 v[36:51], a[140:143], a[28:31], v[36:51]
    ds_read_b64_tr_b16 a[4:5], v19 offset:20480
    ds_read_b64_tr_b16 a[6:7], v19 offset:20992
    v_lshlrev_b32 v54, 16, v215
    v_and_b32 v55, 0xffff0000, v215
    s_waitcnt lgkmcnt(5)
    v_mfma_f32_32x32x16_bf16 v[36:51], a[144:147], a[32:35], v[36:51]
    ds_read_b64_tr_b16 a[8:9], v19 offset:22528
    ds_read_b64_tr_b16 a[10:11], v19 offset:23040
    ds_write_b128 v11, v[124:127] offset:53248
    s_waitcnt lgkmcnt(6)
    v_mfma_f32_32x32x16_bf16 v[36:51], a[148:151], a[0:3], v[36:51]
    ds_read_b64_tr_b16 a[12:13], v19 offset:24576
    ds_read_b64_tr_b16 a[14:15], v19 offset:25088
    v_lshlrev_b32 v56, 16, v216
    v_and_b32 v57, 0xffff0000, v216
    s_waitcnt lgkmcnt(5)
    v_mfma_f32_32x32x16_bf16 v[36:51], a[152:155], a[4:7], v[36:51]
    ds_read_b64_tr_b16 a[16:17], v19 offset:26624
    ds_read_b64_tr_b16 a[18:19], v19 offset:27136
    ds_write_b128 v11, v[128:131] offset:54272
    s_waitcnt lgkmcnt(6)
    v_mfma_f32_32x32x16_bf16 v[36:51], a[156:159], a[8:11], v[36:51]
    ds_read_b64_tr_b16 a[20:21], v19 offset:28672
    ds_read_b64_tr_b16 a[22:23], v19 offset:29184
    v_lshlrev_b32 v58, 16, v217
    v_and_b32 v59, 0xffff0000, v217
    s_waitcnt lgkmcnt(5)
    v_mfma_f32_32x32x16_bf16 v[36:51], a[160:163], a[12:15], v[36:51]
    ds_read_b64_tr_b16 a[24:25], v19 offset:30720
    ds_read_b64_tr_b16 a[26:27], v19 offset:31232
    ds_write_b128 v11, v[132:135] offset:55296
    s_waitcnt lgkmcnt(6)
    v_mfma_f32_32x32x16_bf16 v[36:51], a[164:167], a[16:19], v[36:51]
    ds_read_b64_tr_b16 a[28:29], v19 offset:32768
    ds_read_b64_tr_b16 a[30:31], v19 offset:33280
    buffer_load_dwordx4 v[68:71], v1, s[44:47], s13 offen sc1
    v_lshlrev_b32 v60, 16, v218
    s_waitcnt lgkmcnt(5)
    v_mfma_f32_32x32x16_bf16 v[36:51], a[168:171], a[20:23], v[36:51]
    ds_read_b64_tr_b16 a[0:1], v19 offset:34816
    ds_read_b64_tr_b16 a[2:3], v19 offset:35328
    buffer_load_dwordx4 v[72:75], v1, s[44:47], s13 offen offset:1024 sc1
    v_and_b32 v61, 0xffff0000, v218
    s_waitcnt lgkmcnt(5)
    v_mfma_f32_32x32x16_bf16 v[36:51], a[172:175], a[24:27], v[36:51]
    ds_read_b64_tr_b16 a[4:5], v19 offset:36864
    ds_read_b64_tr_b16 a[6:7], v19 offset:37376
    ds_write_b128 v11, v[136:139] offset:56320
    s_waitcnt lgkmcnt(5)
    v_mfma_f32_32x32x16_bf16 v[36:51], a[176:179], a[28:31], v[36:51]
    ds_read_b64_tr_b16 a[8:9], v19 offset:38912
    ds_read_b64_tr_b16 a[10:11], v19 offset:39424
    buffer_load_dwordx4 v[76:79], v1, s[44:47], s13 offen offset:2048 sc1
    v_lshlrev_b32 v62, 16, v219
    s_waitcnt lgkmcnt(5)
    v_mfma_f32_32x32x16_bf16 v[36:51], a[180:183], a[0:3], v[36:51]
    ds_read_b64_tr_b16 a[12:13], v19 offset:40960
    ds_read_b64_tr_b16 a[14:15], v19 offset:41472
    buffer_load_dwordx4 v[80:83], v1, s[44:47], s13 offen offset:3072 sc1
    v_and_b32 v63, 0xffff0000, v219
    s_waitcnt lgkmcnt(5)
    v_mfma_f32_32x32x16_bf16 v[36:51], a[184:187], a[4:7], v[36:51]
    ds_read_b64_tr_b16 a[16:17], v19 offset:43008
    ds_read_b64_tr_b16 a[18:19], v19 offset:43520
    ds_write_b128 v12, v[140:143] offset:57344
    s_waitcnt lgkmcnt(5)
    v_mfma_f32_32x32x16_bf16 v[36:51], a[188:191], a[8:11], v[36:51]
    ds_read_b64_tr_b16 a[20:21], v19 offset:45056
    ds_read_b64_tr_b16 a[22:23], v19 offset:45568
    v_lshlrev_b32_e64 v64, 16, v220
    v_and_b32 v65, 0xffff0000, v220
    s_waitcnt lgkmcnt(5)
    v_mfma_f32_32x32x16_bf16 v[36:51], a[192:195], a[12:15], v[36:51]
    ds_read_b64_tr_b16 a[24:25], v19 offset:47104
    ds_read_b64_tr_b16 a[26:27], v19 offset:47616
    ds_write_b128 v12, v[144:147] offset:58368
    s_waitcnt lgkmcnt(6)
    v_mfma_f32_32x32x16_bf16 v[36:51], a[196:199], a[16:19], v[36:51]
    ds_read_b64_tr_b16 a[28:29], v19 offset:49152
    ds_read_b64_tr_b16 a[30:31], v19 offset:49664
    v_lshlrev_b32 v66, 16, v221
    v_and_b32 v67, 0xffff0000, v221
    s_waitcnt lgkmcnt(5)
    v_mfma_f32_32x32x16_bf16 v[36:51], a[200:203], a[20:23], v[36:51]
    ds_read_b64_tr_b16 a[0:1], v19 offset:51200
    ds_read_b64_tr_b16 a[2:3], v19 offset:51712
    ds_write_b128 v12, v[148:151] offset:59392
    s_waitcnt lgkmcnt(6)
    v_mfma_f32_32x32x16_bf16 v[36:51], a[204:207], a[24:27], v[36:51]
    ds_read_b64_tr_b16 a[32:33], v19 offset:53248
    ds_read_b64_tr_b16 a[34:35], v19 offset:53760
    ds_write_b128 v12, v[152:155] offset:60416
    s_waitcnt lgkmcnt(6)
    v_mfma_f32_32x32x16_bf16 v[36:51], a[208:211], a[28:31], v[36:51]
    ds_read_b64_tr_b16 a[4:5], v19 offset:55296
    ds_read_b64_tr_b16 a[6:7], v19 offset:55808
    s_waitcnt lgkmcnt(2)
    s_barrier
    ds_read_b128 v[2:5], v18 offset:49152
    v_mfma_f32_32x32x16_bf16 v[36:51], a[212:215], a[0:3], v[36:51]
    ds_read_b128 v[6:9], v18 offset:53248
    ds_read_b128 v[20:23], v18 offset:57344
    ds_read_b128 v[24:27], v18 offset:50176
    ds_read_b128 v[28:31], v18 offset:54272
    ds_read_b128 v[84:87], v18 offset:58368
    v_mfma_f32_32x32x16_bf16 v[36:51], a[216:219], a[32:35], v[36:51]
    ds_read_b128 v[88:91], v18 offset:51200
    ds_read_b128 v[92:95], v18 offset:55296
    ds_read_b128 v[96:99], v18 offset:59392
    ds_read_b128 v[100:103], v18 offset:52224
    ds_read_b128 v[104:107], v18 offset:56320
    s_waitcnt lgkmcnt(11)
    v_mfma_f32_32x32x16_bf16 v[36:51], a[220:223], a[4:7], v[36:51]
    ds_read_b128 v[108:111], v18 offset:60416
    s_waitcnt lgkmcnt(11)
    v_pk_add_f32 v[156:157], v[156:157], v[2:3]
    v_pk_add_f32 v[158:159], v[158:159], v[4:5]
    s_waitcnt lgkmcnt(10)
    v_pk_add_f32 v[156:157], v[156:157], v[6:7]
    v_pk_add_f32 v[158:159], v[158:159], v[8:9]
    s_waitcnt lgkmcnt(9)
    v_pk_add_f32 v[156:157], v[156:157], v[20:21]
    v_pk_add_f32 v[158:159], v[158:159], v[22:23]
    s_waitcnt lgkmcnt(8)
    v_pk_add_f32 v[160:161], v[160:161], v[24:25]
    v_pk_add_f32 v[162:163], v[162:163], v[26:27]
    s_waitcnt lgkmcnt(7)
    v_pk_add_f32 v[160:161], v[160:161], v[28:29]
    v_pk_add_f32 v[162:163], v[162:163], v[30:31]
    s_waitcnt lgkmcnt(6)
    v_pk_add_f32 v[160:161], v[160:161], v[84:85]
    v_pk_add_f32 v[162:163], v[162:163], v[86:87]
    s_waitcnt lgkmcnt(5)
    v_pk_add_f32 v[164:165], v[164:165], v[88:89]
    v_pk_add_f32 v[166:167], v[166:167], v[90:91]
    s_waitcnt lgkmcnt(4)
    v_pk_add_f32 v[164:165], v[164:165], v[92:93]
    v_pk_add_f32 v[166:167], v[166:167], v[94:95]
    s_waitcnt lgkmcnt(3)
    v_pk_add_f32 v[164:165], v[164:165], v[96:97]
    v_pk_add_f32 v[166:167], v[166:167], v[98:99]
    s_waitcnt lgkmcnt(2)
    v_pk_add_f32 v[168:169], v[168:169], v[100:101]
    v_pk_add_f32 v[170:171], v[170:171], v[102:103]
    s_waitcnt lgkmcnt(1)
    v_pk_add_f32 v[168:169], v[168:169], v[104:105]
    v_pk_add_f32 v[170:171], v[170:171], v[106:107]
    s_waitcnt lgkmcnt(0)
    v_pk_add_f32 v[168:169], v[168:169], v[108:109]
    v_pk_add_f32 v[170:171], v[170:171], v[110:111]
    v_mov_b32 v10, 0xbfb8aa3b
    v_mov_b32 v11, 0xbfb8aa3b
    v_mov_b32 v12, 1.0
    v_mov_b32 v13, 1.0
    s_mov_b32 s65, 0x0c0c0400
    s_mov_b32 s66, 0x04000c0c
    s_waitcnt vmcnt(0)
    v_perm_b32 v18, v69, v68, s65
    v_perm_b32 v19, v71, v70, s66
    v_or_b32 v20, v18, v19
    v_or_b32 v21, v18, v19
    v_perm_b32 v18, v73, v72, s65
    v_perm_b32 v19, v75, v74, s66
    v_or_b32 v18, v18, v19
    v_and_b32 v20, v20, v18
    v_or_b32_e64 v21, v21, v18
    v_perm_b32 v18, v77, v76, s65
    v_perm_b32 v19, v79, v78, s66
    v_or_b32 v18, v18, v19
    v_and_b32 v20, v20, v18
    v_or_b32_e64 v21, v21, v18
    v_perm_b32 v18, v81, v80, s65
    v_perm_b32 v19, v83, v82, s66
    v_or_b32 v18, v18, v19
    v_and_b32 v20, v20, v18
    v_or_b32 v21, v21, v18
    v_xor_b32 v20, s62, v20
    v_xor_b32 v21, s62, v21
    v_or_b32 v20, v20, v21
    v_cmp_eq_u32 vcc, 0, v20
    s_nop 0
    s_cmp_eq_u64 vcc, exec
    s_cbranch_scc0 L_slow8
L_ok8:
    v_and_b32 v68, s63, v68
    v_and_b32 v69, s63, v69
    v_and_b32 v70, s63, v70
    v_and_b32 v71, s63, v71
    v_and_b32 v72, s63, v72
    v_and_b32 v73, s63, v73
    v_and_b32 v74, s63, v74
    v_and_b32 v75, s63, v75
    v_pk_add_f32 v[156:157], v[156:157], v[68:69]
    v_pk_add_f32 v[158:159], v[158:159], v[70:71]
    v_pk_add_f32 v[160:161], v[160:161], v[72:73]
    v_pk_add_f32 v[162:163], v[162:163], v[74:75]
    v_pk_mul_f32 v[2:3], v[156:157], v[10:11]
    v_pk_mul_f32 v[4:5], v[158:159], v[10:11]
    v_pk_mul_f32 v[6:7], v[160:161], v[10:11]
    v_pk_mul_f32 v[8:9], v[162:163], v[10:11]
    v_exp_f32 v2, v2
    v_exp_f32 v3, v3
    v_exp_f32 v4, v4
    v_exp_f32 v5, v5
    v_exp_f32 v6, v6
    v_exp_f32 v7, v7
    v_exp_f32 v8, v8
    v_exp_f32 v9, v9
    v_pk_mul_f32 v[156:157], v[156:157], v[36:37]
    v_pk_mul_f32 v[158:159], v[158:159], v[38:39]
    v_pk_mul_f32 v[160:161], v[160:161], v[40:41]
    v_pk_mul_f32 v[162:163], v[162:163], v[42:43]
    v_pk_add_f32 v[2:3], v[2:3], v[12:13]
    v_pk_add_f32 v[4:5], v[4:5], v[12:13]
    v_pk_add_f32 v[6:7], v[6:7], v[12:13]
    v_pk_add_f32 v[8:9], v[8:9], v[12:13]
    v_rcp_f32 v2, v2
    v_rcp_f32 v3, v3
    v_rcp_f32 v4, v4
    v_rcp_f32 v5, v5
    v_rcp_f32 v6, v6
    v_rcp_f32 v7, v7
    v_rcp_f32 v8, v8
    v_rcp_f32 v9, v9
    v_pk_fma_f32 v[52:53], v[156:157], v[2:3], v[52:53]
    v_pk_fma_f32 v[54:55], v[158:159], v[4:5], v[54:55]
    v_pk_fma_f32 v[56:57], v[160:161], v[6:7], v[56:57]
    v_pk_fma_f32 v[58:59], v[162:163], v[8:9], v[58:59]
    v_cvt_pk_bf16_f32 v18, v52, v53
    v_cvt_pk_bf16_f32 v19, v54, v55
    v_cvt_pk_bf16_f32 v20, v56, v57
    v_cvt_pk_bf16_f32 v21, v58, v59
    s_nop 0
    v_permlane32_swap_b32 v18, v20
    v_permlane32_swap_b32 v19, v21
    buffer_store_dwordx4 v[18:21], v17, s[40:43], 0 offen
    v_and_b32 v76, s63, v76
    v_and_b32 v77, s63, v77
    v_and_b32 v78, s63, v78
    v_and_b32 v79, s63, v79
    v_and_b32 v80, s63, v80
    v_and_b32 v81, s63, v81
    v_and_b32 v82, s63, v82
    v_and_b32_e64 v83, s63, v83
    v_pk_add_f32 v[164:165], v[164:165], v[76:77]
    v_pk_add_f32 v[166:167], v[166:167], v[78:79]
    v_pk_add_f32 v[168:169], v[168:169], v[80:81]
    v_pk_add_f32 v[170:171], v[170:171], v[82:83]
    v_pk_mul_f32 v[84:85], v[164:165], v[10:11]
    v_pk_mul_f32 v[86:87], v[166:167], v[10:11]
    v_pk_mul_f32 v[88:89], v[168:169], v[10:11]
    v_pk_mul_f32 v[90:91], v[170:171], v[10:11]
    v_exp_f32 v84, v84
    v_exp_f32 v85, v85
    v_exp_f32 v86, v86
    v_exp_f32 v87, v87
    v_exp_f32 v88, v88
    v_exp_f32 v89, v89
    v_exp_f32 v90, v90
    v_exp_f32 v91, v91
    v_pk_mul_f32 v[164:165], v[164:165], v[44:45]
    v_pk_mul_f32 v[166:167], v[166:167], v[46:47]
    v_pk_mul_f32 v[168:169], v[168:169], v[48:49]
    v_pk_mul_f32 v[170:171], v[170:171], v[50:51]
    v_pk_add_f32 v[84:85], v[84:85], v[12:13]
    v_pk_add_f32 v[86:87], v[86:87], v[12:13]
    v_pk_add_f32 v[88:89], v[88:89], v[12:13]
    v_pk_add_f32 v[90:91], v[90:91], v[12:13]
    v_rcp_f32 v84, v84
    v_rcp_f32 v85, v85
    v_rcp_f32 v86, v86
    v_rcp_f32 v87, v87
    v_rcp_f32 v88, v88
    v_rcp_f32 v89, v89
    v_rcp_f32 v90, v90
    v_rcp_f32 v91, v91
    v_pk_fma_f32 v[60:61], v[164:165], v[84:85], v[60:61]
    v_pk_fma_f32 v[62:63], v[166:167], v[86:87], v[62:63]
    v_pk_fma_f32 v[64:65], v[168:169], v[88:89], v[64:65]
    v_pk_fma_f32 v[66:67], v[170:171], v[90:91], v[66:67]
    v_cvt_pk_bf16_f32 v22, v60, v61
    v_cvt_pk_bf16_f32 v23, v62, v63
    v_cvt_pk_bf16_f32 v24, v64, v65
    v_cvt_pk_bf16_f32 v25, v66, v67
    s_nop 0
    v_permlane32_swap_b32 v22, v24
    v_permlane32_swap_b32 v23, v25
    buffer_store_dwordx4 v[22:25], v17, s[40:43], 0 offen offset:32
    s_or_b32 s65, s101, s52
    s_cmp_eq_u32 s65, 0
    s_cselect_b32 s65, 0, 0x7ffffff0
    buffer_store_dword v34, v33, s[44:47], s65 offen

    s_endpgm
L_slow0:
    s_movk_i32 s100, 0x4000
L_spin0:
    s_sleep 4
    buffer_load_dwordx4 v[148:151], v10, s[44:47], s65 offen sc1
    buffer_load_dwordx4 v[152:155], v10, s[44:47], s66 offen sc1
    buffer_load_dwordx2 v[188:189], v43, s[44:47], s19 offen sc1
    buffer_load_dwordx2 v[190:191], v43, s[44:47], s19 offen offset:1024 sc1
    buffer_load_dwordx2 v[192:193], v43, s[44:47], s19 offen offset:128 sc1
    buffer_load_dwordx2 v[194:195], v43, s[44:47], s19 offen offset:1152 sc1
    s_waitcnt vmcnt(0)
    v_and_b32 v8, v150, v154
    v_or_b32_e64 v9, v150, v154
    v_bitop3_b32 v8, v8, v189, v191 bitop3:0x80
    v_or3_b32 v9, v9, v189, v191
    v_bitop3_b32 v8, v8, v193, v195 bitop3:0x80
    v_or3_b32 v9, v9, v193, v195
    v_xor_b32 v8, s62, v8
    v_xor_b32 v9, s62, v9
    v_or_b32_e64 v8, v8, v9
    v_cmp_eq_u32 vcc, 0, v8
    s_nop 0
    s_cmp_eq_u64 vcc, exec
    s_cbranch_scc1 L_ok0
    s_sub_u32 s100, s100, 1
    s_cmp_lg_u32 s100, 0
    s_cbranch_scc1 L_spin0
    s_branch L_ok0
L_slow1:
    s_movk_i32 s100, 0x4000
L_spin1:
    s_sleep 4
    buffer_load_dwordx2 v[44:45], v43, s[44:47], s86 offen sc1
    buffer_load_dwordx2 v[46:47], v43, s[44:47], s86 offen offset:1024 sc1
    buffer_load_dwordx2 v[48:49], v43, s[44:47], s86 offen offset:128 sc1
    buffer_load_dwordx2 v[50:51], v43, s[44:47], s86 offen offset:1152 sc1
    s_waitcnt vmcnt(0)
    v_and_b32 v14, v45, v47
    v_or_b32_e64 v15, v45, v47
    v_bitop3_b32 v14, v14, v49, v51 bitop3:0x80
    v_or3_b32 v15, v15, v49, v51
    v_xor_b32 v14, s62, v14
    v_xor_b32 v15, s62, v15
    v_or_b32 v14, v14, v15
    v_cmp_eq_u32 vcc, 0, v14
    s_nop 0
    s_cmp_eq_u64 vcc, exec
    s_cbranch_scc1 L_ok1
    s_sub_u32 s100, s100, 1
    s_cmp_lg_u32 s100, 0
    s_cbranch_scc1 L_spin1
    s_branch L_ok1
L_slow2:
    s_movk_i32 s100, 0x4000
L_spin2:
    s_sleep 8
    buffer_load_dword v32, v40, s[44:47], s90 offen sc1
    s_waitcnt vmcnt(0)
    v_cmp_eq_u32 vcc, s62, v32
    s_nop 0
    s_cmp_eq_u64 vcc, exec
    s_cbranch_scc1 L_ok2
    s_sub_u32 s100, s100, 1
    s_cmp_lg_u32 s100, 0
    s_cbranch_scc1 L_spin2
    s_branch L_ok2
L_slow3:
    s_movk_i32 s100, 0x4000
L_spin3:
    s_sleep 8
    buffer_load_dword v13, v38, s[44:47], s49 offen sc1
    s_waitcnt vmcnt(0)
    v_cmp_eq_u32 vcc, s62, v13
    s_nop 0
    s_cmp_eq_u64 vcc, exec
    s_cbranch_scc1 L_ok3
    s_sub_u32 s100, s100, 1
    s_cmp_lg_u32 s100, 0
    s_cbranch_scc1 L_spin3
    s_branch L_ok3
L_slow4:
    s_movk_i32 s100, 0x4000
L_spin4:
    s_sleep 8
    buffer_load_dword v7, v40, s[44:47], s51 offen sc1
    s_waitcnt vmcnt(0)
    v_cmp_eq_u32 vcc, s62, v7
    s_nop 0
    s_cmp_eq_u64 vcc, exec
    s_cbranch_scc1 L_ok4
    s_sub_u32 s100, s100, 1
    s_cmp_lg_u32 s100, 0
    s_cbranch_scc1 L_spin4
    s_branch L_ok4
L_slow5:
    s_movk_i32 s100, 0x4000
L_spin5:
    s_sleep 8
    buffer_load_dword v13, v42, s[44:47], s22 offen sc1
    s_waitcnt vmcnt(0)
    v_cmp_eq_u32 vcc, s62, v13
    s_nop 0
    s_cmp_eq_u64 vcc, exec
    s_cbranch_scc1 L_ok5
    s_sub_u32 s100, s100, 1
    s_cmp_lg_u32 s100, 0
    s_cbranch_scc1 L_spin5
    s_branch L_ok5
L_slow6:
    s_movk_i32 s100, 0x4000
L_spin6:
    s_sleep 8
    buffer_load_dword v13, v42, s[44:47], s89 offen sc1
    s_waitcnt vmcnt(0)
    v_cmp_eq_u32 vcc, s62, v13
    s_nop 0
    s_cmp_eq_u64 vcc, exec
    s_cbranch_scc1 L_ok6
    s_sub_u32 s100, s100, 1
    s_cmp_lg_u32 s100, 0
    s_cbranch_scc1 L_spin6
    s_branch L_ok6
L_slow7:
    s_movk_i32 s100, 0x2000
    s_mov_b32 s0, m0
L_spin7:
    s_sleep 4
    s_add_u32 m0, s21, 106496
    s_mov_b32 s1, s73
    buffer_load_dwordx4 v15, s[44:47], s1 offen sc1 lds
    s_add_u32 m0, m0, 1024
    s_add_u32 s1, s1, 32768
    buffer_load_dwordx4 v15, s[44:47], s1 offen sc1 lds
    s_add_u32 m0, m0, 1024
    s_add_u32 s1, s1, 32768
    buffer_load_dwordx4 v15, s[44:47], s1 offen sc1 lds
    s_add_u32 m0, m0, 1024
    s_add_u32 s1, s1, 32768
    buffer_load_dwordx4 v15, s[44:47], s1 offen sc1 lds
    s_add_u32 m0, m0, 1024
    s_add_u32 s1, s1, 32768
    buffer_load_dwordx4 v15, s[44:47], s1 offen sc1 lds
    s_add_u32 m0, m0, 1024
    s_add_u32 s1, s1, 32768
    buffer_load_dwordx4 v15, s[44:47], s1 offen sc1 lds
    s_add_u32 m0, m0, 1024
    s_add_u32 s1, s1, 32768
    buffer_load_dwordx4 v15, s[44:47], s1 offen sc1 lds
    s_add_u32 m0, m0, 1024
    s_add_u32 s1, s1, 32768
    buffer_load_dwordx4 v15, s[44:47], s1 offen sc1 lds
    s_add_u32 m0, m0, 1024
    s_add_u32 s1, s1, 32768
    buffer_load_dwordx4 v15, s[44:47], s1 offen sc1 lds
    s_add_u32 m0, m0, 1024
    s_add_u32 s1, s1, 32768
    buffer_load_dwordx4 v15, s[44:47], s1 offen sc1 lds
    s_add_u32 m0, m0, 1024
    s_add_u32 s1, s1, 32768
    buffer_load_dwordx4 v15, s[44:47], s1 offen sc1 lds
    s_add_u32 m0, m0, 1024
    s_add_u32 s1, s1, 32768
    buffer_load_dwordx4 v15, s[44:47], s1 offen sc1 lds
    s_add_u32 m0, m0, 1024
    s_add_u32 s1, s1, 32768
    buffer_load_dwordx4 v15, s[44:47], s1 offen sc1 lds
    s_add_u32 m0, m0, 1024
    s_add_u32 s1, s1, 32768
    buffer_load_dwordx4 v15, s[44:47], s1 offen sc1 lds
    s_add_u32 m0, m0, 1024
    s_add_u32 s1, s1, 32768

    s_waitcnt vmcnt(0)
    ds_read_b32 v52, v16
    ds_read_b32 v53, v16 offset:1024
    ds_read_b32 v54, v16 offset:2048
    ds_read_b32 v55, v16 offset:3072
    ds_read_b32 v56, v16 offset:4096
    ds_read_b32 v57, v16 offset:5120
    ds_read_b32 v58, v16 offset:6144
    ds_read_b32 v59, v16 offset:7168
    ds_read_b32 v60, v16 offset:8192
    ds_read_b32 v61, v16 offset:9216
    ds_read_b32 v62, v16 offset:10240
    ds_read_b32 v63, v16 offset:11264
    ds_read_b32 v64, v16 offset:12288
    ds_read_b32 v65, v16 offset:13312
    s_waitcnt lgkmcnt(0)
    v_max3_u32 v52, v52, v53, v54
    v_max3_u32 v52, v52, v55, v56
    v_max3_u32 v52, v52, v57, v58
    v_max3_u32 v52, v52, v59, v60
    v_max3_u32 v52, v52, v61, v62
    v_max3_u32 v52, v52, v63, v64
    v_max_u32_e64 v52, v52, v65
    v_cmp_ne_u32 vcc, -1, v52
    s_mov_b32 m0, s0
    s_cmp_eq_u64 vcc, exec
    s_cbranch_scc1 L_ok7
    s_sub_u32 s100, s100, 1
    s_cmp_lg_u32 s100, 0
    s_cbranch_scc1 L_spin7
    s_branch L_ok7
L_slow8:
    s_movk_i32 s100, 0x4000
L_spin8:
    s_sleep 4
    buffer_load_dwordx4 v[68:71], v1, s[44:47], s13 offen sc1
    buffer_load_dwordx4 v[72:75], v1, s[44:47], s13 offen offset:1024 sc1
    buffer_load_dwordx4 v[76:79], v1, s[44:47], s13 offen offset:2048 sc1
    buffer_load_dwordx4 v[80:83], v1, s[44:47], s13 offen offset:3072 sc1
    s_waitcnt vmcnt(0)
    v_perm_b32 v18, v69, v68, s65
    v_perm_b32 v19, v71, v70, s66
    v_or_b32 v20, v18, v19
    v_or_b32_e64 v21, v18, v19
    v_perm_b32 v18, v73, v72, s65
    v_perm_b32 v19, v75, v74, s66
    v_or_b32 v18, v18, v19
    v_and_b32 v20, v20, v18
    v_or_b32_e64 v21, v21, v18
    v_perm_b32 v18, v77, v76, s65
    v_perm_b32 v19, v79, v78, s66
    v_or_b32 v18, v18, v19
    v_and_b32 v20, v20, v18
    v_or_b32_e64 v21, v21, v18
    v_perm_b32 v18, v81, v80, s65
    v_perm_b32 v19, v83, v82, s66
    v_or_b32 v18, v18, v19
    v_and_b32 v20, v20, v18
    v_or_b32 v21, v21, v18
    v_xor_b32 v20, s62, v20
    v_xor_b32 v21, s62, v21
    v_or_b32 v20, v20, v21
    v_cmp_eq_u32 vcc, 0, v20
    s_nop 0
    s_cmp_eq_u64 vcc, exec
    s_cbranch_scc1 L_ok8
    s_sub_u32 s100, s100, 1
    s_cmp_lg_u32 s100, 0
    s_cbranch_scc1 L_spin8
    s_branch L_ok8

L_helper:
    s_load_dwordx4 s[4:7], s[0:1], 8
    s_load_dwordx2 s[44:45], s[0:1], 72
    v_lshlrev_b32 v1, 4, v0
    s_lshr_b32 s53, s52, 1
    s_and_b32 s54, s52, 1
    s_mov_b32 s101, s2
    s_and_b32 s58, s2, 7
    s_sub_u32 s63, s57, 28
    s_lshl_b32 s55, s58, 2
    s_add_u32 s55, s55, s63
    s_and_b32 s59, s58, 3
    s_lshl_b32 s59, s59, 2
    s_add_u32 s59, s59, s63
    s_lshr_b32 s64, s58, 2
    s_mul_i32 s56, s64, 7
    s_lshr_b32 s64, s59, 1
    s_add_u32 s56, s56, s64
    s_and_b32 s60, s59, 1
    v_lshrrev_b32 v8, 3, v0
    v_and_b32 v9, 7, v0
    v_mul_u32_u24 v10, 3584, v8
    v_lshl_add_u32 v10, v9, 4, v10
    s_lshl_b32 s63, s60, 1
    s_add_u32 s63, s63, s53
    s_mul_i32 s63, s63, 401408
    s_lshl_b32 s66, s56, 8
    s_add_u32 s63, s63, s66
    s_cmp_lt_u32 s59, 14
    s_cselect_b32 s63, s63, 0x7efffff0
    s_waitcnt lgkmcnt(0)
    s_load_dword s62, s[44:45], 0
    s_cmp_eq_u32 s54, 0
    s_cselect_b32 s48, s28, s32
    s_cselect_b32 s49, s29, s33
    s_mov_b32 s50, 0x188000
    s_mov_b32 s51, 0x20000
    s_add_u32 s64, s63, 0
    buffer_load_dwordx4 v[18:21], v10, s[48:51], s64 offen
    s_add_u32 s64, s63, 28672
    buffer_load_dwordx4 v[22:25], v10, s[48:51], s64 offen
    s_add_u32 s64, s63, 57344
    buffer_load_dwordx4 v[26:29], v10, s[48:51], s64 offen
    s_add_u32 s64, s63, 86016
    buffer_load_dwordx4 v[30:33], v10, s[48:51], s64 offen
    s_add_u32 s64, s63, 114688
    buffer_load_dwordx4 v[34:37], v10, s[48:51], s64 offen
    s_add_u32 s64, s63, 143360
    buffer_load_dwordx4 v[38:41], v10, s[48:51], s64 offen
    s_add_u32 s64, s63, 172032
    buffer_load_dwordx4 v[42:45], v10, s[48:51], s64 offen
    s_add_u32 s64, s63, 200704
    buffer_load_dwordx4 v[46:49], v10, s[48:51], s64 offen
    s_add_u32 s64, s63, 229376
    buffer_load_dwordx4 v[50:53], v10, s[48:51], s64 offen
    s_add_u32 s64, s63, 258048
    buffer_load_dwordx4 v[54:57], v10, s[48:51], s64 offen
    s_add_u32 s64, s63, 286720
    buffer_load_dwordx4 v[58:61], v10, s[48:51], s64 offen
    s_add_u32 s64, s63, 315392
    buffer_load_dwordx4 v[62:65], v10, s[48:51], s64 offen
    s_add_u32 s64, s63, 344064
    buffer_load_dwordx4 v[66:69], v10, s[48:51], s64 offen
    s_add_u32 s64, s63, 372736
    buffer_load_dwordx4 v[70:73], v10, s[48:51], s64 offen
    s_cmp_eq_u32 s54, 0
    s_cselect_b32 s28, s4, s6
    s_cselect_b32 s29, s5, s7
    s_mov_b32 s30, 0xe1000
    s_mov_b32 s31, 0x20000
    s_mov_b32 s46, 0x1500000
    s_mov_b32 s47, 0x20000
    s_mul_i32 s11, s55, 900
    s_mul_i32 s66, s53, 460800
    s_add_u32 s11, s11, s66
    s_lshl_b32 s12, s54, 15
    s_lshl_b32 s66, s53, 14
    s_add_u32 s12, s12, s66
    s_add_u32 s12, s12, 4096
    s_lshl_b32 s67, s52, 6
    v_add_u32 v17, s67, v0
    v_mov_b32 v82, 0x7ffffff0
    s_waitcnt lgkmcnt(0)
    s_mul_i32 s62, s62, 0x9e3779b1
    s_add_u32 s62, s62, 0x7f4a7c15
    v_cmp_eq_u32_e64 vcc, 0, v17
    v_mov_b32 v11, s62
    s_nop 0
    v_cndmask_b32 v12, v82, 0, vcc
    v_lshrrev_b32 v83, 5, v0
    v_lshlrev_b32 v84, 3, v9
    v_lshl_add_u32 v84, v83, 2, v84
    v_bfe_u32 v83, v0, 4, 1
    v_lshl_add_u32 v84, v83, 1, v84
    v_and_b32_e64 v83, 1, v8
    v_add_u32 v84, v84, v83
    s_lshl_b32 s66, s52, 8
    v_lshl_add_u32 v13, v84, 2, s66
    v_lshl_add_u32 v14, v0, 2, s66
    v_lshlrev_b32 v15, 1, v14
    s_lshl_b32 s68, s56, 11
    s_lshl_b32 s66, s60, 10
    s_add_u32 s68, s68, s66
    s_add_u32 s68, s68, 262144
    s_cmp_lt_u32 s59, 14
    s_cselect_b32 s68, s68, 0x7efffff0
    s_cmp_lt_u32 s52, 2
    s_cselect_b32 s68, s68, 0x7efffff0
    v_mov_b32 v16, v83
    s_mov_b32 s65, 0x3f80
    s_mov_b32 s66, 0x3f800000
    s_waitcnt vmcnt(13)
    v_dot2_f32_bf16 v74, v18, s65, 0
    v_dot2_f32_bf16 v75, v18, s66, 0
    v_dot2_f32_bf16 v76, v19, s65, 0
    v_dot2_f32_bf16 v77, v19, s66, 0
    v_dot2_f32_bf16 v78, v20, s65, 0
    v_dot2_f32_bf16 v79, v20, s66, 0
    v_dot2_f32_bf16 v80, v21, s65, 0
    v_dot2_f32_bf16 v81, v21, s66, 0
    s_add_u32 m0, s12, 0
    s_add_u32 s64, s11, 0
    buffer_load_dwordx4 v1, s[28:31], s64 offen lds
    s_waitcnt vmcnt(13)
    v_dot2_f32_bf16 v74, v22, s65, v74
    v_dot2_f32_bf16 v75, v22, s66, v75
    v_dot2_f32_bf16 v76, v23, s65, v76
    v_dot2_f32_bf16 v77, v23, s66, v77
    v_dot2_f32_bf16 v78, v24, s65, v78
    v_dot2_f32_bf16 v79, v24, s66, v79
    v_dot2_f32_bf16 v80, v25, s65, v80
    v_dot2_f32_bf16 v81, v25, s66, v81
    s_add_u32 m0, s12, 1024
    s_add_u32 s64, s11, 28800
    buffer_load_dwordx4 v1, s[28:31], s64 offen lds
    s_waitcnt vmcnt(13)
    v_dot2_f32_bf16 v74, v26, s65, v74
    v_dot2_f32_bf16 v75, v26, s66, v75
    v_dot2_f32_bf16 v76, v27, s65, v76
    v_dot2_f32_bf16 v77, v27, s66, v77
    v_dot2_f32_bf16 v78, v28, s65, v78
    v_dot2_f32_bf16 v79, v28, s66, v79
    v_dot2_f32_bf16 v80, v29, s65, v80
    v_dot2_f32_bf16 v81, v29, s66, v81
    s_add_u32 m0, s12, 2048
    s_add_u32 s64, s11, 57600
    buffer_load_dwordx4 v1, s[28:31], s64 offen lds
    s_waitcnt vmcnt(13)
    v_dot2_f32_bf16 v74, v30, s65, v74
    v_dot2_f32_bf16 v75, v30, s66, v75
    v_dot2_f32_bf16 v76, v31, s65, v76
    v_dot2_f32_bf16 v77, v31, s66, v77
    v_dot2_f32_bf16 v78, v32, s65, v78
    v_dot2_f32_bf16 v79, v32, s66, v79
    v_dot2_f32_bf16 v80, v33, s65, v80
    v_dot2_f32_bf16 v81, v33, s66, v81
    s_add_u32 m0, s12, 3072
    s_add_u32 s64, s11, 86400
    buffer_load_dwordx4 v1, s[28:31], s64 offen lds
    s_waitcnt vmcnt(13)
    v_dot2_f32_bf16 v74, v34, s65, v74
    v_dot2_f32_bf16 v75, v34, s66, v75
    v_dot2_f32_bf16 v76, v35, s65, v76
    v_dot2_f32_bf16 v77, v35, s66, v77
    v_dot2_f32_bf16 v78, v36, s65, v78
    v_dot2_f32_bf16 v79, v36, s66, v79
    v_dot2_f32_bf16 v80, v37, s65, v80
    v_dot2_f32_bf16 v81, v37, s66, v81
    s_add_u32 m0, s12, 4096
    s_add_u32 s64, s11, 115200
    buffer_load_dwordx4 v1, s[28:31], s64 offen lds
    s_waitcnt vmcnt(13)
    v_dot2_f32_bf16 v74, v38, s65, v74
    v_dot2_f32_bf16 v75, v38, s66, v75
    v_dot2_f32_bf16 v76, v39, s65, v76
    v_dot2_f32_bf16 v77, v39, s66, v77
    v_dot2_f32_bf16 v78, v40, s65, v78
    v_dot2_f32_bf16 v79, v40, s66, v79
    v_dot2_f32_bf16 v80, v41, s65, v80
    v_dot2_f32_bf16 v81, v41, s66, v81
    s_add_u32 m0, s12, 5120
    s_add_u32 s64, s11, 144000
    buffer_load_dwordx4 v1, s[28:31], s64 offen lds
    s_waitcnt vmcnt(13)
    v_dot2_f32_bf16 v74, v42, s65, v74
    v_dot2_f32_bf16 v75, v42, s66, v75
    v_dot2_f32_bf16 v76, v43, s65, v76
    v_dot2_f32_bf16 v77, v43, s66, v77
    v_dot2_f32_bf16 v78, v44, s65, v78
    v_dot2_f32_bf16 v79, v44, s66, v79
    v_dot2_f32_bf16 v80, v45, s65, v80
    v_dot2_f32_bf16 v81, v45, s66, v81
    s_add_u32 m0, s12, 6144
    s_add_u32 s64, s11, 172800
    buffer_load_dwordx4 v1, s[28:31], s64 offen lds
    s_waitcnt vmcnt(13)
    v_dot2_f32_bf16 v74, v46, s65, v74
    v_dot2_f32_bf16 v75, v46, s66, v75
    v_dot2_f32_bf16 v76, v47, s65, v76
    v_dot2_f32_bf16 v77, v47, s66, v77
    v_dot2_f32_bf16 v78, v48, s65, v78
    v_dot2_f32_bf16 v79, v48, s66, v79
    v_dot2_f32_bf16 v80, v49, s65, v80
    v_dot2_f32_bf16 v81, v49, s66, v81
    s_add_u32 m0, s12, 7168
    s_add_u32 s64, s11, 201600
    buffer_load_dwordx4 v1, s[28:31], s64 offen lds
    s_waitcnt vmcnt(13)
    v_dot2_f32_bf16 v74, v50, s65, v74
    v_dot2_f32_bf16 v75, v50, s66, v75
    v_dot2_f32_bf16 v76, v51, s65, v76
    v_dot2_f32_bf16 v77, v51, s66, v77
    v_dot2_f32_bf16 v78, v52, s65, v78
    v_dot2_f32_bf16 v79, v52, s66, v79
    v_dot2_f32_bf16 v80, v53, s65, v80
    v_dot2_f32_bf16 v81, v53, s66, v81
    s_add_u32 m0, s12, 8192
    s_add_u32 s64, s11, 230400
    buffer_load_dwordx4 v1, s[28:31], s64 offen lds
    s_waitcnt vmcnt(13)
    v_dot2_f32_bf16 v74, v54, s65, v74
    v_dot2_f32_bf16 v75, v54, s66, v75
    v_dot2_f32_bf16 v76, v55, s65, v76
    v_dot2_f32_bf16 v77, v55, s66, v77
    v_dot2_f32_bf16 v78, v56, s65, v78
    v_dot2_f32_bf16 v79, v56, s66, v79
    v_dot2_f32_bf16 v80, v57, s65, v80
    v_dot2_f32_bf16 v81, v57, s66, v81
    s_add_u32 m0, s12, 9216
    s_add_u32 s64, s11, 259200
    buffer_load_dwordx4 v1, s[28:31], s64 offen lds
    s_waitcnt vmcnt(13)
    v_dot2_f32_bf16 v74, v58, s65, v74
    v_dot2_f32_bf16 v75, v58, s66, v75
    v_dot2_f32_bf16 v76, v59, s65, v76
    v_dot2_f32_bf16 v77, v59, s66, v77
    v_dot2_f32_bf16 v78, v60, s65, v78
    v_dot2_f32_bf16 v79, v60, s66, v79
    v_dot2_f32_bf16 v80, v61, s65, v80
    v_dot2_f32_bf16 v81, v61, s66, v81
    s_waitcnt vmcnt(12)
    v_dot2_f32_bf16 v74, v62, s65, v74
    v_dot2_f32_bf16 v75, v62, s66, v75
    v_dot2_f32_bf16 v76, v63, s65, v76
    v_dot2_f32_bf16 v77, v63, s66, v77
    v_dot2_f32_bf16 v78, v64, s65, v78
    v_dot2_f32_bf16 v79, v64, s66, v79
    v_dot2_f32_bf16 v80, v65, s65, v80
    v_dot2_f32_bf16 v81, v65, s66, v81
    s_waitcnt vmcnt(11)
    v_dot2_f32_bf16 v74, v66, s65, v74
    v_dot2_f32_bf16 v75, v66, s66, v75
    v_dot2_f32_bf16 v76, v67, s65, v76
    v_dot2_f32_bf16 v77, v67, s66, v77
    v_dot2_f32_bf16 v78, v68, s65, v78
    v_dot2_f32_bf16 v79, v68, s66, v79
    v_dot2_f32_bf16 v80, v69, s65, v80
    v_dot2_f32_bf16 v81, v69, s66, v81
    s_waitcnt vmcnt(10)
    v_dot2_f32_bf16 v74, v70, s65, v74
    v_dot2_f32_bf16 v75, v70, s66, v75
    v_dot2_f32_bf16 v76, v71, s65, v76
    v_dot2_f32_bf16 v77, v71, s66, v77
    v_dot2_f32_bf16 v78, v72, s65, v78
    v_dot2_f32_bf16 v79, v72, s66, v79
    v_dot2_f32_bf16 v80, v73, s65, v80
    v_dot2_f32_bf16 v81, v73, s66, v81
    v_cmp_eq_u32 vcc, 0, v16
    v_permlane32_swap_b32 v74, v78
    v_permlane32_swap_b32 v75, v79
    v_permlane32_swap_b32 v76, v80
    v_permlane32_swap_b32 v77, v81
    v_add_f32 v74, v74, v78
    v_add_f32 v75, v75, v79
    v_add_f32 v76, v76, v80
    v_add_f32 v77, v77, v81
    s_nop 0
    v_permlane16_swap_b32 v74, v76
    v_permlane16_swap_b32 v75, v77
    v_add_f32 v74, v74, v76
    v_add_f32 v75, v75, v77
    v_cndmask_b32_e64 v84, v75, v74, vcc
    v_cndmask_b32 v85, v74, v75, vcc
    s_nop 1
    v_add_f32_dpp v84, v85, v84 row_ror:8 row_mask:0xf bank_mask:0xf
    ds_write_b32 v13, v84
    s_waitcnt lgkmcnt(0)
    s_barrier
    ds_read2st64_b32 v[82:83], v14 offset0:0 offset1:2
    s_waitcnt lgkmcnt(0)
    v_add_f32 v82, v82, v83
    v_mov_b32_e64 v83, s62
    buffer_store_dwordx2 v[82:83], v15, s[44:47], s68 offen sc1
    s_add_u32 s68, s68, 28672
    s_add_u32 m0, s12, 10240
    s_add_u32 s64, s11, 288000
    buffer_load_dwordx4 v1, s[28:31], s64 offen lds
    s_add_u32 m0, s12, 11264
    s_add_u32 s64, s11, 316800
    buffer_load_dwordx4 v1, s[28:31], s64 offen lds
    s_add_u32 m0, s12, 12288
    s_add_u32 s64, s11, 345600
    buffer_load_dwordx4 v1, s[28:31], s64 offen lds
    s_add_u32 m0, s12, 13312
    s_add_u32 s64, s11, 374400
    buffer_load_dwordx4 v1, s[28:31], s64 offen lds
    s_add_u32 m0, s12, 14336
    s_add_u32 s64, s11, 403200
    buffer_load_dwordx4 v1, s[28:31], s64 offen lds
    s_add_u32 m0, s12, 15360
    s_add_u32 s64, s11, 432000
    buffer_load_dwordx4 v1, s[28:31], s64 offen lds
    s_add_u32 s64, s63, 0
    buffer_load_dwordx4 v[18:21], v10, s[48:51], s64 offen offset:128
    s_add_u32 s64, s63, 28672
    buffer_load_dwordx4 v[22:25], v10, s[48:51], s64 offen offset:128
    s_add_u32 s64, s63, 57344
    buffer_load_dwordx4 v[26:29], v10, s[48:51], s64 offen offset:128
    s_add_u32 s64, s63, 86016
    buffer_load_dwordx4 v[30:33], v10, s[48:51], s64 offen offset:128
    s_add_u32 s64, s63, 114688
    buffer_load_dwordx4 v[34:37], v10, s[48:51], s64 offen offset:128
    s_add_u32 s64, s63, 143360
    buffer_load_dwordx4 v[38:41], v10, s[48:51], s64 offen offset:128
    v_lshlrev_b32 v158, 2, v17
    v_add_u32 v158, 4096, v158
    v_mul_u32_u24 v166, 144, v17
    v_add_u32 v166, 69632, v166
    s_mov_b32 s65, 0x05040100
    s_mov_b32 s66, 0x07060302
    s_waitcnt vmcnt(6)
    s_barrier
    v_mov_b32 v138, -1
    v_mov_b32 v139, -1
    v_mov_b32_e64 v140, -1
    v_mov_b32 v141, -1
    s_lshl_b32 s70, s55, 2
    s_add_u32 s70, s70, s52
    s_mul_i32 s70, s70, 14336
    s_add_u32 s70, s70, 3145728
    ds_read2st64_b32 v[74:75], v158 offset0:0 offset1:4
    ds_read2st64_b32 v[106:107], v158 offset0:128 offset1:132
    ds_read2st64_b32 v[76:77], v158 offset0:8 offset1:12
    ds_read2st64_b32 v[108:109], v158 offset0:136 offset1:140
    ds_read2st64_b32 v[78:79], v158 offset0:16 offset1:20
    ds_read2st64_b32 v[110:111], v158 offset0:144 offset1:148
    ds_read2st64_b32 v[80:81], v158 offset0:24 offset1:28
    ds_read2st64_b32 v[112:113], v158 offset0:152 offset1:156
    ds_read2st64_b32 v[82:83], v158 offset0:32 offset1:36
    ds_read2st64_b32 v[114:115], v158 offset0:160 offset1:164
    ds_read2st64_b32 v[84:85], v158 offset0:40 offset1:44
    ds_read2st64_b32 v[116:117], v158 offset0:168 offset1:172
    ds_read2st64_b32 v[86:87], v158 offset0:48 offset1:52
    ds_read2st64_b32 v[118:119], v158 offset0:176 offset1:180
    ds_read2st64_b32 v[88:89], v158 offset0:56 offset1:60
    ds_read2st64_b32 v[120:121], v158 offset0:184 offset1:188
    ds_read2st64_b32 v[90:91], v158 offset0:64 offset1:68
    ds_read2st64_b32 v[122:123], v158 offset0:192 offset1:196
    ds_read2st64_b32 v[92:93], v158 offset0:72 offset1:76
    ds_read2st64_b32 v[124:125], v158 offset0:200 offset1:204
    ds_read2st64_b32 v[94:95], v158 offset0:80 offset1:84
    ds_read2st64_b32 v[126:127], v158 offset0:208 offset1:212
    ds_read2st64_b32 v[96:97], v158 offset0:88 offset1:92
    ds_read2st64_b32 v[128:129], v158 offset0:216 offset1:220
    ds_read2st64_b32 v[98:99], v158 offset0:96 offset1:100
    ds_read2st64_b32 v[130:131], v158 offset0:224 offset1:228
    ds_read2st64_b32 v[100:101], v158 offset0:104 offset1:108
    ds_read2st64_b32 v[132:133], v158 offset0:232 offset1:236
    ds_read2st64_b32 v[102:103], v158 offset0:112 offset1:116
    ds_read2st64_b32 v[134:135], v158 offset0:240 offset1:244
    ds_read2st64_b32 v[104:105], v158 offset0:120 offset1:124
    ds_read2st64_b32 v[136:137], v158 offset0:248 offset1:252
    s_add_u32 s64, s63, 172032
    buffer_load_dwordx4 v[42:45], v10, s[48:51], s64 offen offset:128
    s_waitcnt lgkmcnt(15)
    v_perm_b32 v142, v106, v74, s65
    v_perm_b32 v143, v107, v75, s65
    v_perm_b32 v144, v108, v76, s65
    v_perm_b32 v145, v109, v77, s65
    ds_write_b128 v166, v[142:145]
    v_perm_b32 v146, v106, v74, s66
    v_perm_b32 v147, v107, v75, s66
    v_perm_b32 v148, v108, v76, s66
    v_perm_b32 v149, v109, v77, s66
    ds_write_b128 v166, v[146:149] offset:36864
    s_add_u32 s64, s63, 200704
    buffer_load_dwordx4 v[46:49], v10, s[48:51], s64 offen offset:128
    v_perm_b32 v150, v110, v78, s65
    v_perm_b32 v151, v111, v79, s65
    v_perm_b32 v152, v112, v80, s65
    v_perm_b32 v153, v113, v81, s65
    ds_write_b128 v166, v[150:153] offset:16
    v_perm_b32 v154, v110, v78, s66
    v_perm_b32 v155, v111, v79, s66
    v_perm_b32 v156, v112, v80, s66
    v_perm_b32 v157, v113, v81, s66
    ds_write_b128 v166, v[154:157] offset:36880
    s_add_u32 s64, s63, 229376
    buffer_load_dwordx4 v[50:53], v10, s[48:51], s64 offen offset:128
    v_perm_b32 v158, v114, v82, s65
    v_perm_b32 v159, v115, v83, s65
    v_perm_b32 v160, v116, v84, s65
    v_perm_b32 v161, v117, v85, s65
    ds_write_b128 v166, v[158:161] offset:32
    v_perm_b32 v142, v114, v82, s66
    v_perm_b32 v143, v115, v83, s66
    v_perm_b32 v144, v116, v84, s66
    v_perm_b32 v145, v117, v85, s66
    ds_write_b128 v166, v[142:145] offset:36896
    s_add_u32 s64, s63, 258048
    buffer_load_dwordx4 v[54:57], v10, s[48:51], s64 offen offset:128
    v_perm_b32 v146, v118, v86, s65
    v_perm_b32 v147, v119, v87, s65
    v_perm_b32 v148, v120, v88, s65
    v_perm_b32 v149, v121, v89, s65
    ds_write_b128 v166, v[146:149] offset:48
    v_perm_b32 v150, v118, v86, s66
    v_perm_b32 v151, v119, v87, s66
    v_perm_b32 v152, v120, v88, s66
    v_perm_b32 v153, v121, v89, s66
    ds_write_b128 v166, v[150:153] offset:36912
    s_add_u32 s64, s63, 286720
    buffer_load_dwordx4 v[58:61], v10, s[48:51], s64 offen offset:128
    s_waitcnt lgkmcnt(15)
    v_perm_b32 v154, v122, v90, s65
    v_perm_b32 v155, v123, v91, s65
    v_perm_b32 v156, v124, v92, s65
    v_perm_b32 v157, v125, v93, s65
    ds_write_b128 v166, v[154:157] offset:64
    v_perm_b32 v158, v122, v90, s66
    v_perm_b32 v159, v123, v91, s66
    v_perm_b32 v160, v124, v92, s66
    v_perm_b32 v161, v125, v93, s66
    ds_write_b128 v166, v[158:161] offset:36928
    s_add_u32 s64, s63, 315392
    buffer_load_dwordx4 v[62:65], v10, s[48:51], s64 offen offset:128
    v_perm_b32 v142, v126, v94, s65
    v_perm_b32 v143, v127, v95, s65
    v_perm_b32 v144, v128, v96, s65
    v_perm_b32 v145, v129, v97, s65
    ds_write_b128 v166, v[142:145] offset:80
    v_perm_b32 v146, v126, v94, s66
    v_perm_b32 v147, v127, v95, s66
    v_perm_b32 v148, v128, v96, s66
    v_perm_b32 v149, v129, v97, s66
    ds_write_b128 v166, v[146:149] offset:36944
    s_add_u32 s64, s63, 344064
    buffer_load_dwordx4 v[66:69], v10, s[48:51], s64 offen offset:128
    s_waitcnt lgkmcnt(15)
    v_perm_b32 v150, v130, v98, s65
    v_perm_b32 v151, v131, v99, s65
    v_perm_b32 v152, v132, v100, s65
    v_perm_b32 v153, v133, v101, s65
    ds_write_b128 v166, v[150:153] offset:96
    v_perm_b32 v154, v130, v98, s66
    v_perm_b32 v155, v131, v99, s66
    v_perm_b32 v156, v132, v100, s66
    v_perm_b32 v157, v133, v101, s66
    ds_write_b128 v166, v[154:157] offset:36960
    s_add_u32 s64, s63, 372736
    buffer_load_dwordx4 v[70:73], v10, s[48:51], s64 offen offset:128
    s_waitcnt lgkmcnt(15)
    v_perm_b32 v158, v134, v102, s65
    v_perm_b32 v159, v135, v103, s65
    s_waitcnt lgkmcnt(14)
    v_perm_b32 v160, v136, v104, s65
    v_perm_b32 v161, v137, v105, s65
    ds_write_b128 v166, v[158:161] offset:112
    v_perm_b32 v142, v134, v102, s66
    v_perm_b32 v143, v135, v103, s66
    v_perm_b32 v144, v136, v104, s66
    v_perm_b32 v145, v137, v105, s66
    ds_write_b128 v166, v[142:145] offset:36976
    v_lshrrev_b32 v167, 4, v17
    v_and_b32 v168, 1, v8
    v_mul_u32_u24 v168, 225, v168
    v_add3_u32 v168, v168, v167, 1
    v_and_b32 v169, 1, v168
    v_lshlrev_b32 v169, 8, v169
    v_lshrrev_b32 v168, 1, v168
    v_add_u32 v169, v169, v168
    v_mul_u32_u24 v169, 144, v169
    v_lshl_add_u32 v169, v9, 4, v169
    v_add_u32 v169, 69632, v169
    v_lshlrev_b32_e64 v167, 13, v167
    v_and_b32 v168, 15, v17
    v_lshl_add_u32 v167, v168, 4, v167
    s_lshl_b32 s67, s55, 8
    s_add_u32 s67, s67, 5242880
    s_waitcnt lgkmcnt(0)
    s_barrier
    ds_read_b128 v[146:149], v169
    ds_read_b128 v[150:153], v169 offset:1152
    ds_read_b128 v[154:157], v169 offset:2304
    ds_read_b128 v[158:161], v169 offset:3456
    ds_read_b128 v[162:165], v169 offset:4608
    ds_read_b128 v[82:85], v169 offset:5760
    ds_read_b128 v[86:89], v169 offset:6912
    ds_read_b128 v[90:93], v169 offset:8064
    ds_read_b128 v[94:97], v169 offset:9216
    ds_read_b128 v[98:101], v169 offset:10368
    ds_read_b128 v[102:105], v169 offset:11520
    ds_read_b128 v[106:109], v169 offset:12672
    ds_read_b128 v[110:113], v169 offset:13824
    ds_read_b128 v[114:117], v169 offset:14976
    s_mov_b32 s65, 0x3f80
    s_mov_b32 s66, 0x3f800000
    s_waitcnt vmcnt(13)
    v_dot2_f32_bf16 v74, v18, s65, 0
    v_dot2_f32_bf16 v75, v18, s66, 0
    v_dot2_f32_bf16 v76, v19, s65, 0
    v_dot2_f32_bf16 v77, v19, s66, 0
    v_dot2_f32_bf16 v78, v20, s65, 0
    v_dot2_f32_bf16 v79, v20, s66, 0
    v_dot2_f32_bf16 v80, v21, s65, 0
    v_dot2_f32_bf16 v81, v21, s66, 0
    s_waitcnt lgkmcnt(13)
    buffer_store_dwordx4 v[146:149], v167, s[44:47], s67 offen sc1
    s_waitcnt vmcnt(13)
    v_dot2_f32_bf16 v74, v22, s65, v74
    v_dot2_f32_bf16 v75, v22, s66, v75
    v_dot2_f32_bf16 v76, v23, s65, v76
    v_dot2_f32_bf16 v77, v23, s66, v77
    v_dot2_f32_bf16 v78, v24, s65, v78
    v_dot2_f32_bf16 v79, v24, s66, v79
    v_dot2_f32_bf16 v80, v25, s65, v80
    v_dot2_f32_bf16 v81, v25, s66, v81
    s_add_u32 s67, s67, 131072
    s_waitcnt lgkmcnt(12)
    buffer_store_dwordx4 v[150:153], v167, s[44:47], s67 offen sc1
    s_waitcnt vmcnt(13)
    v_dot2_f32_bf16 v74, v26, s65, v74
    v_dot2_f32_bf16 v75, v26, s66, v75
    v_dot2_f32_bf16 v76, v27, s65, v76
    v_dot2_f32_bf16 v77, v27, s66, v77
    v_dot2_f32_bf16 v78, v28, s65, v78
    v_dot2_f32_bf16 v79, v28, s66, v79
    v_dot2_f32_bf16 v80, v29, s65, v80
    v_dot2_f32_bf16 v81, v29, s66, v81
    s_add_u32 s67, s67, 131072
    s_waitcnt lgkmcnt(11)
    buffer_store_dwordx4 v[154:157], v167, s[44:47], s67 offen sc1
    s_waitcnt vmcnt(13)
    v_dot2_f32_bf16 v74, v30, s65, v74
    v_dot2_f32_bf16 v75, v30, s66, v75
    v_dot2_f32_bf16 v76, v31, s65, v76
    v_dot2_f32_bf16 v77, v31, s66, v77
    v_dot2_f32_bf16 v78, v32, s65, v78
    v_dot2_f32_bf16 v79, v32, s66, v79
    v_dot2_f32_bf16 v80, v33, s65, v80
    v_dot2_f32_bf16 v81, v33, s66, v81
    s_add_u32 s67, s67, 131072
    s_waitcnt lgkmcnt(10)
    buffer_store_dwordx4 v[158:161], v167, s[44:47], s67 offen sc1
    s_waitcnt vmcnt(13)
    v_dot2_f32_bf16 v74, v34, s65, v74
    v_dot2_f32_bf16 v75, v34, s66, v75
    v_dot2_f32_bf16 v76, v35, s65, v76
    v_dot2_f32_bf16 v77, v35, s66, v77
    v_dot2_f32_bf16 v78, v36, s65, v78
    v_dot2_f32_bf16 v79, v36, s66, v79
    v_dot2_f32_bf16 v80, v37, s65, v80
    v_dot2_f32_bf16 v81, v37, s66, v81
    s_add_u32 s67, s67, 131072
    s_waitcnt lgkmcnt(9)
    buffer_store_dwordx4 v[162:165], v167, s[44:47], s67 offen sc1
    s_waitcnt vmcnt(13)
    v_dot2_f32_bf16 v74, v38, s65, v74
    v_dot2_f32_bf16 v75, v38, s66, v75
    v_dot2_f32_bf16 v76, v39, s65, v76
    v_dot2_f32_bf16 v77, v39, s66, v77
    v_dot2_f32_bf16 v78, v40, s65, v78
    v_dot2_f32_bf16 v79, v40, s66, v79
    v_dot2_f32_bf16 v80, v41, s65, v80
    v_dot2_f32_bf16 v81, v41, s66, v81
    s_add_u32 s67, s67, 131072
    s_waitcnt lgkmcnt(8)
    buffer_store_dwordx4 v[82:85], v167, s[44:47], s67 offen sc1
    s_waitcnt vmcnt(13)
    v_dot2_f32_bf16 v74, v42, s65, v74
    v_dot2_f32_bf16 v75, v42, s66, v75
    v_dot2_f32_bf16 v76, v43, s65, v76
    v_dot2_f32_bf16 v77, v43, s66, v77
    v_dot2_f32_bf16 v78, v44, s65, v78
    v_dot2_f32_bf16 v79, v44, s66, v79
    v_dot2_f32_bf16 v80, v45, s65, v80
    v_dot2_f32_bf16 v81, v45, s66, v81
    s_add_u32 s67, s67, 131072
    s_waitcnt lgkmcnt(7)
    buffer_store_dwordx4 v[86:89], v167, s[44:47], s67 offen sc1
    s_waitcnt vmcnt(13)
    v_dot2_f32_bf16 v74, v46, s65, v74
    v_dot2_f32_bf16 v75, v46, s66, v75
    v_dot2_f32_bf16 v76, v47, s65, v76
    v_dot2_f32_bf16 v77, v47, s66, v77
    v_dot2_f32_bf16 v78, v48, s65, v78
    v_dot2_f32_bf16 v79, v48, s66, v79
    v_dot2_f32_bf16 v80, v49, s65, v80
    v_dot2_f32_bf16 v81, v49, s66, v81
    s_add_u32 s67, s67, 131072
    s_waitcnt lgkmcnt(6)
    buffer_store_dwordx4 v[90:93], v167, s[44:47], s67 offen sc1
    s_waitcnt vmcnt(13)
    v_dot2_f32_bf16 v74, v50, s65, v74
    v_dot2_f32_bf16 v75, v50, s66, v75
    v_dot2_f32_bf16 v76, v51, s65, v76
    v_dot2_f32_bf16 v77, v51, s66, v77
    v_dot2_f32_bf16 v78, v52, s65, v78
    v_dot2_f32_bf16 v79, v52, s66, v79
    v_dot2_f32_bf16 v80, v53, s65, v80
    v_dot2_f32_bf16 v81, v53, s66, v81
    s_add_u32 s67, s67, 131072
    s_waitcnt lgkmcnt(5)
    buffer_store_dwordx4 v[94:97], v167, s[44:47], s67 offen sc1
    s_waitcnt vmcnt(13)
    v_dot2_f32_bf16 v74, v54, s65, v74
    v_dot2_f32_bf16 v75, v54, s66, v75
    v_dot2_f32_bf16 v76, v55, s65, v76
    v_dot2_f32_bf16 v77, v55, s66, v77
    v_dot2_f32_bf16 v78, v56, s65, v78
    v_dot2_f32_bf16 v79, v56, s66, v79
    v_dot2_f32_bf16 v80, v57, s65, v80
    v_dot2_f32_bf16 v81, v57, s66, v81
    s_add_u32 s67, s67, 131072
    s_waitcnt lgkmcnt(4)
    buffer_store_dwordx4 v[98:101], v167, s[44:47], s67 offen sc1
    s_waitcnt vmcnt(13)
    v_dot2_f32_bf16 v74, v58, s65, v74
    v_dot2_f32_bf16 v75, v58, s66, v75
    v_dot2_f32_bf16 v76, v59, s65, v76
    v_dot2_f32_bf16 v77, v59, s66, v77
    v_dot2_f32_bf16 v78, v60, s65, v78
    v_dot2_f32_bf16 v79, v60, s66, v79
    v_dot2_f32_bf16 v80, v61, s65, v80
    v_dot2_f32_bf16 v81, v61, s66, v81
    s_add_u32 s67, s67, 131072
    s_waitcnt lgkmcnt(3)
    buffer_store_dwordx4 v[102:105], v167, s[44:47], s67 offen sc1
    s_waitcnt vmcnt(13)
    v_dot2_f32_bf16 v74, v62, s65, v74
    v_dot2_f32_bf16 v75, v62, s66, v75
    v_dot2_f32_bf16 v76, v63, s65, v76
    v_dot2_f32_bf16 v77, v63, s66, v77
    v_dot2_f32_bf16 v78, v64, s65, v78
    v_dot2_f32_bf16 v79, v64, s66, v79
    v_dot2_f32_bf16 v80, v65, s65, v80
    v_dot2_f32_bf16 v81, v65, s66, v81
    s_add_u32 s67, s67, 131072
    s_waitcnt lgkmcnt(2)
    buffer_store_dwordx4 v[106:109], v167, s[44:47], s67 offen sc1
    s_waitcnt vmcnt(13)
    v_dot2_f32_bf16 v74, v66, s65, v74
    v_dot2_f32_bf16 v75, v66, s66, v75
    v_dot2_f32_bf16 v76, v67, s65, v76
    v_dot2_f32_bf16 v77, v67, s66, v77
    v_dot2_f32_bf16 v78, v68, s65, v78
    v_dot2_f32_bf16 v79, v68, s66, v79
    v_dot2_f32_bf16 v80, v69, s65, v80
    v_dot2_f32_bf16 v81, v69, s66, v81
    s_add_u32 s67, s67, 131072
    s_waitcnt lgkmcnt(1)
    buffer_store_dwordx4 v[110:113], v167, s[44:47], s67 offen sc1
    s_waitcnt vmcnt(13)
    v_dot2_f32_bf16 v74, v70, s65, v74
    v_dot2_f32_bf16 v75, v70, s66, v75
    v_dot2_f32_bf16 v76, v71, s65, v76
    v_dot2_f32_bf16 v77, v71, s66, v77
    v_dot2_f32_bf16 v78, v72, s65, v78
    v_dot2_f32_bf16 v79, v72, s66, v79
    v_dot2_f32_bf16 v80, v73, s65, v80
    v_dot2_f32_bf16 v81, v73, s66, v81
    s_add_u32 s67, s67, 131072
    s_waitcnt lgkmcnt(0)
    buffer_store_dwordx4 v[114:117], v167, s[44:47], s67 offen sc1
    v_cmp_eq_u32 vcc, 0, v16
    v_permlane32_swap_b32 v74, v78
    v_permlane32_swap_b32 v75, v79
    v_permlane32_swap_b32 v76, v80
    v_permlane32_swap_b32 v77, v81
    v_add_f32 v74, v74, v78
    v_add_f32 v75, v75, v79
    v_add_f32 v76, v76, v80
    v_add_f32 v77, v77, v81
    s_nop 0
    v_permlane16_swap_b32 v74, v76
    v_permlane16_swap_b32 v75, v77
    v_add_f32 v74, v74, v76
    v_add_f32 v75, v75, v77
    v_cndmask_b32 v10, v75, v74, vcc
    v_cndmask_b32 v17, v74, v75, vcc
    s_nop 1
    v_add_f32_dpp v10, v17, v10 row_ror:8 row_mask:0xf bank_mask:0xf
    ds_write_b32 v13, v10 offset:1024
    s_waitcnt lgkmcnt(0)
    s_barrier
    ds_read2st64_b32 v[8:9], v14 offset0:4 offset1:6
    s_waitcnt lgkmcnt(0)
    v_add_f32 v8, v8, v9
    v_mov_b32 v9, s62
    buffer_store_dwordx2 v[8:9], v15, s[44:47], s68 offen sc1
    s_add_u32 s68, s68, 28672
    s_waitcnt vmcnt(1)
    s_barrier
    s_lshl_b32 s65, s55, 6
    s_add_u32 s65, s65, 22528
    buffer_store_dword v11, v12, s[44:47], s65 offen sc1
    buffer_store_dwordx4 v[138:141], v1, s[44:47], s70 offen sc1
    buffer_store_dwordx4 v[138:141], v1, s[44:47], s70 offen offset:1024 sc1
    buffer_store_dwordx4 v[138:141], v1, s[44:47], s70 offen offset:2048 sc1
    buffer_store_dwordx4 v[138:141], v1, s[44:47], s70 offen offset:3072 sc1
    s_add_u32 s70, s70, 4096
    buffer_store_dwordx4 v[138:141], v1, s[44:47], s70 offen sc1
    buffer_store_dwordx4 v[138:141], v1, s[44:47], s70 offen offset:1024 sc1
    buffer_store_dwordx4 v[138:141], v1, s[44:47], s70 offen offset:2048 sc1
    buffer_store_dwordx4 v[138:141], v1, s[44:47], s70 offen offset:3072 sc1
    s_add_u32 s70, s70, 4096
    buffer_store_dwordx4 v[138:141], v1, s[44:47], s70 offen sc1
    buffer_store_dwordx4 v[138:141], v1, s[44:47], s70 offen offset:1024 sc1
    buffer_store_dwordx4 v[138:141], v1, s[44:47], s70 offen offset:2048 sc1
    buffer_store_dwordx4 v[138:141], v1, s[44:47], s70 offen offset:3072 sc1
    s_add_u32 s70, s70, 4096
    buffer_store_dwordx4 v[138:141], v1, s[44:47], s70 offen sc1
    buffer_store_dwordx4 v[138:141], v1, s[44:47], s70 offen offset:1024 sc1
    s_waitcnt vmcnt(0)
    s_barrier
    buffer_store_dword v11, v12, s[44:47], s65 offen offset:2048 sc1

L_end:
    s_endpgm
.fill (32768 + 64 - (. - recurrent_scan__spectral_gfnet__glu_gated_swiglu__prompt_kernel)) / 4, 4, 0xbf810000
.section .rodata,"a"
.p2align 6
.amdhsa_kernel recurrent_scan__spectral_gfnet__glu_gated_swiglu__prompt_kernel
  .amdhsa_next_free_vgpr 496
  .amdhsa_next_free_sgpr 102
  .amdhsa_accum_offset 240
  .amdhsa_group_segment_fixed_size 0
  .amdhsa_kernarg_size 80
  .amdhsa_user_sgpr_count 2
  .amdhsa_user_sgpr_kernarg_segment_ptr 1
  .amdhsa_system_sgpr_workgroup_id_x 1
.end_amdhsa_kernel
```
